```python
import torch

def _softmax(x, axis=-1):
    return torch.softmax(x, dim=axis)
def _gelu(x):
    return torch.nn.functional.gelu(x, approximate="tanh")
def _silu(x):
    return torch.nn.functional.silu(x)
def _sigmoid(x):
    return torch.sigmoid(x)
def _layernorm(x, axis=-1, eps=1e-5):
    m = x.mean(dim=axis, keepdim=True)
    v = x.var(dim=axis, keepdim=True, unbiased=False)
    return (x - m) / torch.sqrt(v + eps)
def _scatter_add(tgt, idx, src, axis=0):
    return tgt.clone().index_add_(axis, idx, src)
def _segment_sum(src, seg, n):
    out = torch.zeros((n,) + src.shape[1:], dtype=src.dtype)
    return out.index_add_(0, seg, src)
def _pad(x, pw):
    flat = tuple(v for pair in reversed(pw) for v in pair)
    return torch.nn.functional.pad(x, flat)

kernel_name = 'standalone__sliding_local_dilated__prompt'

def setup_inputs():

    _w = (lambda a: (lambda t: t.to(torch.bfloat16) if t.is_floating_point() else t)(torch.as_tensor(a)))
    B, S, D = 1, 2048, 576
    return {
        "x": _w((lambda *s: torch.randn(*s, dtype=torch.bfloat16) * 0.2)(B, S, D)),
        "wqkv": _w((lambda *s: torch.randn(*s, dtype=torch.bfloat16) * 0.2)(D, 3 * D)),
        "wo": _w((lambda *s: torch.randn(*s, dtype=torch.bfloat16) * 0.05)(D, D)),
    }

def reference(x, wqkv, wo):
    B, S, D = x.shape
    H = 32; Dh = D // H
    W, dil = 8, 2
    qkv = (lambda x, *d: x.permute(*d))((x @ wqkv).reshape(B, S, 3, H, Dh), 2, 0, 3, 1, 4)
    q, k, v = qkv[0], qkv[1], qkv[2]
    scale = Dh ** -0.5
    pos = torch.arange(S)
    off = torch.arange(W) * dil
    idx = pos[:, None] - off[None, :]
    mask = idx >= 0
    idx_c = torch.where(mask, idx, 0).reshape(-1)
    kg = k[:, :, idx_c, :].reshape(B, H, S, W, Dh)
    vg = v[:, :, idx_c, :].reshape(B, H, S, W, Dh)
    logits = torch.einsum("bhsd,bhswd->bhsw", q, kg) * scale
    logits = torch.where(mask[None, None, :, :], logits, -1e9)
    attn = _softmax(logits, axis=-1)
    o = torch.einsum("bhsw,bhswd->bhsd", attn, vg)
    return (lambda x, *d: x.permute(*d))(o, 0, 2, 1, 3).reshape(B, S, D) @ wo
```

```asm
; @launch grid=(256,1,1) block=(512,1,1) lds=163840
.amdgcn_target "amdgcn-amd-amdhsa--gfx950"
.text
.globl standalone__sliding_local_dilated__prompt_kernel
.p2align 8
.type standalone__sliding_local_dilated__prompt_kernel,@function
standalone__sliding_local_dilated__prompt_kernel:
    s_load_dwordx2 s[4:5], s[0:1], 0
    s_load_dwordx2 s[8:9], s[0:1], 8
    s_getpc_b64 s[46:47]
    s_lshr_b32 s29, s2, 3
    s_and_b32 s42, s29, 15
    s_mul_i32 s42, s42, 11
    v_subrev_u32 v3, 256, v0
    v_add_lshl_u32 v2, v3, s42, 7
    v_cmp_gt_u32 vcc, 11, v3
    v_readfirstlane_b32 s38, v0
    s_and_saveexec_b64 s[58:59], vcc
    s_cbranch_execz L_nopf
    global_load_dword v208, v2, s[46:47]
L_nopf:
    s_mov_b64 exec, -1
    s_load_dwordx4 s[12:15], s[0:1], 16
    s_load_dwordx4 s[24:27], s[0:1], 32
    s_lshr_b32 s32, s38, 6
    s_and_b32 s28, s2, 7
    s_mov_b32 s6, 2359296
    s_mov_b32 s7, 0x20000
    s_mov_b32 s10, 1990656
    s_mov_b32 s11, s7
    s_cmp_ge_u32 s29, 27
    s_cbranch_scc1 L_help
    s_mul_i32 s30, s29, 57
    s_lshr_b32 s30, s30, 9
    s_mul_i32 s42, s30, 9
    s_sub_u32 s31, s29, s42
    s_lshr_b32 s33, s28, 1
    s_mul_i32 s33, s33, 3
    s_add_u32 s33, s33, s30
    s_mul_i32 s34, s33, 170
    s_and_b32 s42, s28, 1
    s_add_u32 s34, s34, s42
    s_xor_b32 s32, s32, 4
    s_cmp_lt_u32 s32, 4
    s_cbranch_scc1 L_comp
    s_lshl_b32 s38, s38, 4
    v_lshrrev_b32 v49, 3, v0
    v_bfe_u32 v48, v0, 4, 3
    v_and_or_b32 v47, v0, 8, v48
    v_and_or_b32 v47, v49, 16, v47
    v_and_b32 v46, 4, v48
    v_xor_b32 v48, v48, v0
    v_and_b32 v48, 7, v48
    v_cmp_gt_u32 vcc, 28, v47
    v_lshl_add_u32 v47, v47, 1, s34
    v_mul_u32_u24 v47, 1152, v47
    v_lshl_add_u32 v240, v48, 4, v47
    v_add_u32 v241, 73728, v240
    v_add_u32 v242, 147456, v240
    v_cndmask_b32 v242, -16, v242, vcc
    v_and_or_b32 v46, v49, 2, v46
    v_xor_b32 v46, v46, v0
    v_and_b32 v46, 7, v46
    s_lshl_b32 s44, s31, 7
    v_lshl_add_u32 v46, v46, 4, s44
    s_and_b32 s42, s30, 1
    s_lshl_b32 s42, s42, 5
    v_or_b32 v50, s42, v49
    s_movk_i32 s43, 3456
    v_mad_u32_u24 v243, v50, s43, v46
    v_xor_b32 v50, 32, v50
    v_mad_u32_u24 v244, v50, s43, v46
    s_bitcmp1_b32 74752, s29
    s_addc_u32 s35, s28, 0
    s_add_u32 m0, s38, 36864
    s_lshl_b32 s36, s35, 7
    s_waitcnt lgkmcnt(0)
    buffer_load_dwordx4 v240, s[4:7], s36 offen lds
    s_addk_i32 m0, 4096
    s_mul_i32 s37, s35, 221184
    buffer_load_dwordx4 v241, s[4:7], s36 offen lds
    s_addk_i32 m0, 4096
    s_nop 0
    buffer_load_dwordx4 v242, s[4:7], s36 offen lds
    s_add_u32 m0, s38, 86016
    s_nop 0
    buffer_load_dwordx4 v243, s[8:11], s37 offen lds
    s_addk_i32 m0, 7040
    s_nop 0
    buffer_load_dwordx4 v243, s[8:11], s37 offen offset:1152 lds
    s_addk_i32 m0, 7040
    s_nop 0
    buffer_load_dwordx4 v243, s[8:11], s37 offen offset:2304 lds
    s_addk_i32 m0, 55552
    s_nop 0
    buffer_load_dwordx4 v244, s[8:11], s37 offen lds
    s_addk_i32 m0, 7040
    s_nop 0
    buffer_load_dwordx4 v244, s[8:11], s37 offen offset:1152 lds
    s_addk_i32 m0, 7040
    s_nop 0
    buffer_load_dwordx4 v244, s[8:11], s37 offen offset:2304 lds
    s_addk_i32 m0, 35072
    s_mul_i32 s68, s31, 11
    s_lshr_b32 s68, s68, 5
    s_mul_i32 s68, s68, 3
    s_sub_u32 s68, s31, s68
    s_mul_i32 s68, s68, 3
    s_add_u32 s68, s68, s30
    s_mov_b32 s69, 2271560481
    s_mov_b32 s70, 135
    s_cmp_eq_u32 s68, 1
    s_cselect_b32 s69, 2017874226, s69
    s_cselect_b32 s70, 120, s70
    s_cmp_eq_u32 s68, 2
    s_cselect_b32 s69, 2270454291, s69
    s_cmp_eq_u32 s68, 4
    s_cselect_b32 s69, 2239112240, s69
    s_cselect_b32 s70, 120, s70
    s_cmp_eq_u32 s68, 5
    s_cselect_b32 s69, 2253861441, s69
    s_cmp_eq_u32 s68, 7
    s_cselect_b32 s69, 1752388626, s69
    s_cselect_b32 s70, 120, s70
    s_cmp_eq_u32 s68, 8
    s_cselect_b32 s69, 1988375841, s69
    s_bfe_u32 s35, s69, 262144
    s_add_u32 s35, s35, s28
    s_sub_u32 s36, s35, 9
    s_min_u32 s35, s35, s36
    s_lshl_b32 s36, s35, 7
    buffer_load_dwordx4 v240, s[4:7], s36 offen lds
    s_addk_i32 m0, 4096
    s_branch L_ool
L_oolb:
    s_mul_i32 s37, s35, 221184
    buffer_load_dwordx4 v241, s[4:7], s36 offen lds
    s_addk_i32 m0, 4096
    s_nop 0
    buffer_load_dwordx4 v242, s[4:7], s36 offen lds
    s_add_u32 m0, s38, 12288
    s_nop 0
    buffer_load_dwordx4 v243, s[8:11], s37 offen lds
    s_addk_i32 m0, 7040
    s_nop 0
    buffer_load_dwordx4 v243, s[8:11], s37 offen offset:1152 lds
    s_addk_i32 m0, 7040
    s_nop 0
    buffer_load_dwordx4 v243, s[8:11], s37 offen offset:2304 lds
    s_addk_i32 m0, 55552
    s_waitcnt vmcnt(9)
    s_barrier
    buffer_load_dwordx4 v244, s[8:11], s37 offen lds
    s_addk_i32 m0, 7040
    s_nop 0
    buffer_load_dwordx4 v244, s[8:11], s37 offen offset:1152 lds
    s_addk_i32 m0, 7040
    s_nop 0
    buffer_load_dwordx4 v244, s[8:11], s37 offen offset:2304 lds
    s_add_u32 m0, s38, 113664
    s_bfe_u32 s35, s69, 262148
    s_add_u32 s35, s35, s28
    s_sub_u32 s36, s35, 9
    s_min_u32 s35, s35, s36
    s_lshl_b32 s36, s35, 7
    s_waitcnt vmcnt(9)
    s_barrier
    buffer_load_dwordx4 v240, s[4:7], s36 offen lds
    s_addk_i32 m0, 4096
    s_mul_i32 s37, s35, 221184
    buffer_load_dwordx4 v241, s[4:7], s36 offen lds
    s_addk_i32 m0, 4096
    s_nop 0
    buffer_load_dwordx4 v242, s[4:7], s36 offen lds
    s_add_u32 m0, s38, 49152
    s_nop 0
    buffer_load_dwordx4 v243, s[8:11], s37 offen lds
    s_addk_i32 m0, 7040
    s_nop 0
    buffer_load_dwordx4 v243, s[8:11], s37 offen offset:1152 lds
    s_addk_i32 m0, 7040
    s_nop 0
    buffer_load_dwordx4 v243, s[8:11], s37 offen offset:2304 lds
    s_addk_i32 m0, 55552
    s_nop 0
    buffer_load_dwordx4 v244, s[8:11], s37 offen lds
    s_addk_i32 m0, 7040
    s_nop 0
    buffer_load_dwordx4 v244, s[8:11], s37 offen offset:1152 lds
    s_addk_i32 m0, 7040
    s_nop 0
    buffer_load_dwordx4 v244, s[8:11], s37 offen offset:2304 lds
    s_bfe_u32 s36, s70, 262144
    s_lshl_b32 s37, s36, 13
    s_add_u32 s37, s37, s38
    s_add_u32 m0, s37, 89088
    s_add_u32 s36, s36, s31
    s_sub_u32 s37, s36, 9
    s_min_u32 s36, s36, s37
    s_mul_i32 s36, s36, 73728
    s_waitcnt vmcnt(9)
    s_barrier
    buffer_load_dwordx4 v245, s[12:15], s36 offen lds
    s_addk_i32 m0, 4096
    s_add_u32 s36, s36, 36864
    buffer_load_dwordx4 v245, s[12:15], s36 offen lds
    s_bfe_u32 s36, s70, 262148
    s_lshl_b32 s37, s36, 13
    s_add_u32 s37, s37, s38
    s_add_u32 m0, s37, 89088
    s_add_u32 s36, s36, s31
    s_sub_u32 s37, s36, 9
    s_min_u32 s36, s36, s37
    s_mul_i32 s36, s36, 73728
    buffer_load_dwordx4 v245, s[12:15], s36 offen lds
    s_addk_i32 m0, 4096
    s_add_u32 s36, s36, 36864
    buffer_load_dwordx4 v245, s[12:15], s36 offen lds
    s_add_u32 m0, s38, 0
    s_bfe_u32 s35, s69, 262152
    s_add_u32 s35, s35, s28
    s_sub_u32 s36, s35, 9
    s_min_u32 s35, s35, s36
    s_lshl_b32 s36, s35, 7
    buffer_load_dwordx4 v240, s[4:7], s36 offen lds
    s_addk_i32 m0, 4096
    s_mul_i32 s37, s35, 221184
    buffer_load_dwordx4 v241, s[4:7], s36 offen lds
    s_addk_i32 m0, 4096
    s_nop 0
    buffer_load_dwordx4 v242, s[4:7], s36 offen lds
    s_add_u32 m0, s38, 86016
    s_nop 0
    buffer_load_dwordx4 v243, s[8:11], s37 offen lds
    s_addk_i32 m0, 7040
    s_nop 0
    buffer_load_dwordx4 v243, s[8:11], s37 offen offset:1152 lds
    s_addk_i32 m0, 7040
    s_waitcnt vmcnt(9)
    s_barrier
    buffer_load_dwordx4 v243, s[8:11], s37 offen offset:2304 lds
    s_addk_i32 m0, 55552
    s_nop 0
    buffer_load_dwordx4 v244, s[8:11], s37 offen lds
    s_addk_i32 m0, 7040
    s_nop 0
    buffer_load_dwordx4 v244, s[8:11], s37 offen offset:1152 lds
    s_addk_i32 m0, 7040
    s_cmp_eq_u32 s32, 7
    s_cbranch_scc0 L_hs0b
    s_lshl_b32 s39, s28, 5
    s_load_dword s41, s[24:25], s39
L_hs0b:
    buffer_load_dwordx4 v244, s[8:11], s37 offen offset:2304 lds
    s_add_u32 m0, s38, 36864
    s_bfe_u32 s35, s69, 262156
    s_add_u32 s35, s35, s28
    s_sub_u32 s36, s35, 9
    s_min_u32 s35, s35, s36
    s_lshl_b32 s36, s35, 7
    buffer_load_dwordx4 v240, s[4:7], s36 offen lds
    s_addk_i32 m0, 4096
    s_mul_i32 s37, s35, 221184
    buffer_load_dwordx4 v241, s[4:7], s36 offen lds
    s_addk_i32 m0, 4096
    s_nop 0
    buffer_load_dwordx4 v242, s[4:7], s36 offen lds
    s_addk_i32 m0, 32768
    s_nop 0
    buffer_load_dwordx4 v243, s[8:11], s37 offen lds
    s_addk_i32 m0, 7040
    s_mov_b32 vcc_lo, 1376257
    s_mov_b32 vcc_hi, 357892437
    s_cmp_eq_u32 s32, 0
    s_cselect_b64 vcc, 0, vcc
    v_cndmask_b32 v9, v46, 0, vcc
    v_cndmask_b32 v48, 0, v47, vcc
    v_lshl_or_b32 v12, v48, 16, v12
    buffer_load_dwordx4 v243, s[8:11], s37 offen offset:1152 lds
    s_addk_i32 m0, 7040
    v_lshrrev_b32 v46, 4, v0
    v_lshlrev_b32 v47, 1, v46
    v_bfe_u32 v48, v0, 1, 3
    s_mul_i32 s42, s31, 228
    s_lshr_b32 s42, s42, 9
    s_mul_i32 s42, s42, 9
    s_lshl_b32 s43, s31, 2
    s_sub_u32 s43, s43, s42
    buffer_load_dwordx4 v243, s[8:11], s37 offen offset:2304 lds
    s_addk_i32 m0, 55552
    v_subrev_u32 v49, s43, v47
    v_ashrrev_i32 v13, 31, v49
    v_add_u32 v49, 1, v49
    v_ashrrev_i32 v14, 31, v49
    buffer_load_dwordx4 v244, s[8:11], s37 offen lds
    s_addk_i32 m0, 7040
    v_subrev_u32 v49, s43, v48
    v_ashrrev_i32 v21, 31, v49
    s_add_u32 s43, s43, 1
    s_cmp_eq_u32 s43, 9
    s_cselect_b32 s43, 0, s43
    buffer_load_dwordx4 v244, s[8:11], s37 offen offset:1152 lds
    s_addk_i32 m0, 7040
    v_subrev_u32 v49, s43, v47
    v_ashrrev_i32 v15, 31, v49
    v_add_u32 v49, 1, v49
    v_ashrrev_i32 v16, 31, v49
    buffer_load_dwordx4 v244, s[8:11], s37 offen offset:2304 lds
    s_add_u32 m0, s38, 73728
    v_subrev_u32 v49, s43, v48
    v_ashrrev_i32 v22, 31, v49
    s_add_u32 s43, s43, 1
    s_cmp_eq_u32 s43, 9
    s_cselect_b32 s43, 0, s43
    s_cmp_eq_u32 s32, 7
    s_cbranch_scc0 L_hs1b
L_hs1c:
    s_waitcnt lgkmcnt(0)
    s_cmp_eq_u32 s41, 0
    s_cbranch_scc1 L_hs1
L_hs1d:
    s_atomic_add s3, s[20:21], 111360
L_hs1b:
    s_bfe_u32 s35, s69, 262160
    s_add_u32 s35, s35, s28
    s_sub_u32 s36, s35, 9
    s_min_u32 s35, s35, s36
    s_lshl_b32 s36, s35, 7
    s_waitcnt vmcnt(9)
    s_barrier
    buffer_load_dwordx4 v240, s[4:7], s36 offen lds
    s_addk_i32 m0, 4096
    v_subrev_u32 v49, s43, v47
    v_ashrrev_i32 v17, 31, v49
    v_add_u32 v49, 1, v49
    v_ashrrev_i32 v18, 31, v49
    s_mul_i32 s37, s35, 221184
    buffer_load_dwordx4 v241, s[4:7], s36 offen lds
    s_addk_i32 m0, 4096
    v_subrev_u32 v49, s43, v48
    v_ashrrev_i32 v23, 31, v49
    s_add_u32 s43, s43, 1
    s_cmp_eq_u32 s43, 9
    s_cselect_b32 s43, 0, s43
    buffer_load_dwordx4 v242, s[4:7], s36 offen lds
    s_addk_i32 m0, 32768
    v_subrev_u32 v49, s43, v47
    v_ashrrev_i32 v19, 31, v49
    v_add_u32 v49, 1, v49
    v_ashrrev_i32 v20, 31, v49
    buffer_load_dwordx4 v243, s[8:11], s37 offen lds
    s_addk_i32 m0, 7040
    v_subrev_u32 v49, s43, v48
    v_ashrrev_i32 v24, 31, v49
    buffer_load_dwordx4 v243, s[8:11], s37 offen offset:1152 lds
    s_addk_i32 m0, 7040
    s_mul_i32 s42, s32, 6144
    s_add_u32 s42, s42, 0
    v_lshl_add_u32 v25, v0, 3, s42
    s_sub_u32 s42, s42, 6144
    s_max_i32 s42, s42, 0
    v_lshl_add_u32 v26, v0, 3, s42
    buffer_load_dwordx4 v243, s[8:11], s37 offen offset:2304 lds
    s_addk_i32 m0, 55552
    s_lshl_b32 s44, s32, 11
    v_lshl_add_u32 v31, v0, 4, s44
    s_add_u32 s42, s44, s48
    s_add_u32 s42, s42, 1024
    buffer_load_dwordx4 v244, s[8:11], s37 offen lds
    s_addk_i32 m0, 7040
    s_add_u32 s43, s42, 4294955520
    s_cmp_eq_u32 s31, 0
    s_cselect_b32 s43, 0x40000000, s43
    s_cselect_b32 s45, 0x40000000, s42
    v_lshl_add_u32 v27, v0, 3, s43
    v_lshl_add_u32 v29, v0, 3, s45
    buffer_load_dwordx4 v244, s[8:11], s37 offen offset:1152 lds
    s_addk_i32 m0, 7040
    s_add_u32 s43, s42, 12288
    s_add_u32 s45, s42, 512
    s_cmp_eq_u32 s31, 8
    s_cselect_b32 s43, 0x40000000, s43
    s_cselect_b32 s45, 0x40000000, s45
    v_lshl_add_u32 v28, v0, 3, s43
    v_lshl_add_u32 v30, v0, 3, s45
    buffer_load_dwordx4 v244, s[8:11], s37 offen offset:2304 lds
    s_add_u32 m0, s38, 113664
    s_lshl_b32 s42, s32, 7
    s_bfe_u32 s35, s69, 262164
    s_add_u32 s35, s35, s28
    s_sub_u32 s36, s35, 9
    s_min_u32 s35, s35, s36
    s_lshl_b32 s36, s35, 7
    buffer_load_dwordx4 v240, s[4:7], s36 offen lds
    s_addk_i32 m0, 4096
    s_add_u32 s42, s42, 110592
    v_and_b32 v47, 15, v0
    v_lshl_add_u32 v33, v47, 2, s42
    s_lshl_b32 s43, s31, 2
    s_add_u32 s42, s42, s43
    v_lshl_add_u32 v32, v0, 20, s42
    s_mul_i32 s37, s35, 221184
    buffer_load_dwordx4 v241, s[4:7], s36 offen lds
    s_addk_i32 m0, 4096
    s_and_b32 s44, s32, 1
    s_waitcnt vmcnt(11)
    s_barrier
    buffer_load_dwordx4 v242, s[4:7], s36 offen lds
    s_add_u32 m0, s38, 86016
    s_mul_i32 s42, s44, 18432
    s_add_u32 s42, s42, 38912
    v_lshl_add_u32 v51, v0, 4, s42
    buffer_load_dwordx4 v243, s[8:11], s37 offen lds
    s_addk_i32 m0, 7040
    v_lshl_add_u32 v49, v0, 3, v25
    v_lshl_add_u32 v50, v0, 3, v26
    buffer_load_dwordx4 v243, s[8:11], s37 offen offset:1152 lds
    s_addk_i32 m0, 7040
    v_lshrrev_b32 v46, 3, v0
    v_mul_u32_u24 v46, 2304, v46
    v_and_b32 v26, 7, v0
    v_lshl_add_u32 v26, v26, 4, v46
    s_add_u32 s42, s34, 16
    s_mul_i32 s42, s42, 1152
    v_add_u32 v26, s42, v26
    buffer_load_dwordx4 v243, s[8:11], s37 offen offset:2304 lds
    s_addk_i32 m0, 55552
    s_mul_i32 s42, s32, 18432
    s_lshl_b32 s43, s31, 7
    s_add_u32 s42, s42, s43
    v_add_u32 v25, s42, v26
    buffer_load_dwordx4 v244, s[8:11], s37 offen lds
    s_addk_i32 m0, 7040
    s_mov_b32 s62, 0x3ffff
    buffer_load_dwordx4 v244, s[8:11], s37 offen offset:1152 lds
    s_addk_i32 m0, 7040
    s_lshr_b32 s42, s38, 4
    v_add_u32 v46, s42, v0
    v_mul_u32_u24 v46, 3, v46
    v_add_u32 v46, s30, v46
    v_cmp_gt_u32 vcc, 288, v46
    s_lshl_b32 s42, s31, 6
    s_add_u32 s42, s42, 160
    v_add_u32 v46, s42, v46
    buffer_load_dwordx4 v244, s[8:11], s37 offen offset:2304 lds
    s_add_u32 m0, s38, 0
    v_subrev_u32 v47, 576, v46
    v_min_u32 v46, v46, v47
    v_mul_u32_u24 v46, 1152, v46
    s_lshl_b32 s42, s31, 7
    v_add_u32 v46, s42, v46
    v_cndmask_b32 v247, -16, v46, vcc
    s_bfe_u32 s35, s69, 262168
    s_add_u32 s35, s35, s28
    s_sub_u32 s36, s35, 9
    s_min_u32 s35, s35, s36
    s_lshl_b32 s36, s35, 7
    buffer_load_dwordx4 v240, s[4:7], s36 offen lds
    s_addk_i32 m0, 4096
    s_mul_i32 s37, s35, 221184
    buffer_load_dwordx4 v241, s[4:7], s36 offen lds
    s_addk_i32 m0, 4096
    s_waitcnt vmcnt(11)
    s_barrier
    buffer_load_dwordx4 v242, s[4:7], s36 offen lds
    s_addk_i32 m0, 4096
    s_nop 0
    buffer_load_dwordx4 v243, s[8:11], s37 offen lds
    s_addk_i32 m0, 7040
    s_cmp_eq_u32 s32, 7
    s_cbranch_scc0 L_hs2b
    s_load_dword s41, s[20:21], 111360 glc
L_hs2b:
    buffer_load_dwordx4 v243, s[8:11], s37 offen offset:1152 lds
    s_addk_i32 m0, 7040
    s_nop 0
    buffer_load_dwordx4 v243, s[8:11], s37 offen offset:2304 lds
    s_addk_i32 m0, 55552
    s_nop 0
    buffer_load_dwordx4 v244, s[8:11], s37 offen lds
    s_addk_i32 m0, 7040
    s_nop 0
    buffer_load_dwordx4 v244, s[8:11], s37 offen offset:1152 lds
    s_addk_i32 m0, 7040
    s_nop 0
    buffer_load_dwordx4 v244, s[8:11], s37 offen offset:2304 lds
    s_addk_i32 m0, 6400
    s_bfe_u32 s35, s69, 262172
    s_add_u32 s35, s35, s28
    s_sub_u32 s36, s35, 9
    s_min_u32 s35, s35, s36
    s_lshl_b32 s36, s35, 7
    buffer_load_dwordx4 v240, s[4:7], s36 offen lds
    s_addk_i32 m0, 4096
    s_mul_i32 s37, s35, 221184
    buffer_load_dwordx4 v241, s[4:7], s36 offen lds
    s_addk_i32 m0, 4096
    s_waitcnt vmcnt(11)
    s_barrier
    buffer_load_dwordx4 v242, s[4:7], s36 offen lds
    s_addk_i32 m0, 4096
    s_nop 0
    buffer_load_dwordx4 v243, s[8:11], s37 offen lds
    s_addk_i32 m0, 7040
    s_nop 0
    buffer_load_dwordx4 v243, s[8:11], s37 offen offset:1152 lds
    s_addk_i32 m0, 7040
    s_nop 0
    buffer_load_dwordx4 v243, s[8:11], s37 offen offset:2304 lds
    s_addk_i32 m0, 55552
    s_nop 0
    buffer_load_dwordx4 v244, s[8:11], s37 offen lds
    s_addk_i32 m0, 7040
    s_cmp_eq_u32 s32, 7
    s_cbranch_scc0 L_hs3b
L_hs3c:
    s_waitcnt lgkmcnt(0)
    s_and_b32 s41, s41, 63
    s_cmp_lt_u32 s41, 9
    s_cbranch_scc1 L_hs3
L_hs3b:
    buffer_load_dwordx4 v244, s[8:11], s37 offen offset:1152 lds
    s_cmp_eq_u32 s32, 7
    s_cselect_b32 s41, 0x100, 0
    s_add_u32 m0, s41, 163328
    s_nop 0
    buffer_load_dword v249, s[20:23], 0 offen sc1 lds
    s_add_u32 m0, s38, 67328
    s_nop 0
    buffer_load_dwordx4 v244, s[8:11], s37 offen offset:2304 lds
    s_addk_i32 m0, 21760
    s_mul_i32 s36, s48, 6
    s_waitcnt vmcnt(10)
    s_barrier
    buffer_load_dwordx4 v245, s[12:15], s36 offen lds
    s_addk_i32 m0, 4096
    s_add_u32 s36, s36, 36864
    buffer_load_dwordx4 v245, s[12:15], s36 offen lds
    s_addk_i32 m0, 4096
    s_mul_i32 s36, s49, 6
    buffer_load_dwordx4 v245, s[12:15], s36 offen lds
    s_addk_i32 m0, 4096
    s_add_u32 s36, s36, 36864
    buffer_load_dwordx4 v245, s[12:15], s36 offen lds
    s_addk_i32 m0, 4096
    s_mul_i32 s36, s50, 6
    buffer_load_dwordx4 v245, s[12:15], s36 offen lds
    s_waitcnt vmcnt(5)
    s_barrier
    v_mov_b32 v45, 163584
    ds_read_b32 v46, v45
    buffer_load_dword v247, v247, s[12:15], 0 offen
    s_mov_b64 s[4:5], s[16:17]
    s_waitcnt lgkmcnt(0)
    v_readfirstlane_b32 s39, v46
    s_mul_i32 s3, s3, 9
    s_cmp_lt_u32 s32, 6
    s_cbranch_scc1 L_attnL
    s_branch L_67
    .p2alignl 12, 0xbf810000
L_67:
    s_cmp_lg_u32 s39, s3
    s_cbranch_scc1 L_attnDq
L_attnDf:
L_attnDs:
    s_setprio 0
    v_add_u32 v246, 4294948864, v245
    s_waitcnt vmcnt(1)
    s_barrier
    s_addk_i32 m0, 4096
    s_add_u32 s36, s36, 36864
    buffer_load_dwordx4 v245, s[12:15], s36 offen lds
    s_addk_i32 m0, 63488
    s_nop 0
    buffer_load_dwordx4 v246, s[12:15], s36 offen lds
    s_addk_i32 m0, 6144
    s_mul_i32 s36, s51, 6
    buffer_load_dwordx4 v245, s[12:15], s36 offen lds
    s_addk_i32 m0, 63488
    s_nop 0
    buffer_load_dwordx4 v246, s[12:15], s36 offen lds
    s_addk_i32 m0, 6144
    s_add_u32 s36, s36, 36864
    buffer_load_dwordx4 v245, s[12:15], s36 offen lds
    s_addk_i32 m0, 63488
    s_nop 0
    buffer_load_dwordx4 v246, s[12:15], s36 offen lds
    s_addk_i32 m0, 6144
    s_mul_i32 s36, s52, 6
    buffer_load_dwordx4 v245, s[12:15], s36 offen lds
    s_addk_i32 m0, 63488
    s_nop 0
    buffer_load_dwordx4 v246, s[12:15], s36 offen lds
    s_addk_i32 m0, 6144
    s_add_u32 s36, s36, 36864
    buffer_load_dwordx4 v245, s[12:15], s36 offen lds
    s_addk_i32 m0, 63488
    s_waitcnt vmcnt(8)
    buffer_load_dwordx4 v246, s[12:15], s36 offen lds
    s_addk_i32 m0, 6144
    s_mul_i32 s36, s53, 6
    s_waitcnt vmcnt(8)
    buffer_load_dwordx4 v245, s[12:15], s36 offen lds
    s_addk_i32 m0, 63488
    s_waitcnt vmcnt(8)
    buffer_load_dwordx4 v246, s[12:15], s36 offen lds
    s_addk_i32 m0, 6144
    s_add_u32 s36, s36, 36864
    s_waitcnt vmcnt(8)
    buffer_load_dwordx4 v245, s[12:15], s36 offen lds
    s_addk_i32 m0, 63488
    s_waitcnt vmcnt(8)
    buffer_load_dwordx4 v246, s[12:15], s36 offen lds
    s_addk_i32 m0, 6144
    s_mul_i32 s36, s54, 6
    s_waitcnt vmcnt(8)
    buffer_load_dwordx4 v245, s[12:15], s36 offen lds
    s_addk_i32 m0, 63488
    s_waitcnt vmcnt(8)
    buffer_load_dwordx4 v246, s[12:15], s36 offen lds
    s_addk_i32 m0, 6144
    s_add_u32 s36, s36, 36864
    s_waitcnt vmcnt(8)
    buffer_load_dwordx4 v245, s[12:15], s36 offen lds
    s_addk_i32 m0, 63488
    s_waitcnt vmcnt(8)
    buffer_load_dwordx4 v246, s[12:15], s36 offen lds
    s_and_b32 s44, s32, 1
    v_mul_u32_u24 v46, 57, v0
    v_lshrrev_b32 v46, 9, v46
    v_mul_u32_u24 v47, 9, v46
    v_sub_u32 v47, v0, v47
    v_mul_u32_u24 v48, 11, v46
    v_lshrrev_b32 v48, 5, v48
    v_mul_u32_u24 v49, 3, v48
    v_sub_u32 v49, v46, v49
    v_cmp_gt_u32 vcc, 54, v0
    v_mad_u32_u24 v48, v48, 9, v47
    v_mov_b32 v46, s31
    v_cndmask_b32 v49, v47, v49, vcc
    v_cndmask_b32 v48, v46, v48, vcc
    v_cndmask_b32 v46, 1, 0, vcc
    v_xor_b32 v46, s44, v46
    v_cmp_eq_u32 vcc, 2, v49
    v_lshl_add_u32 v47, v46, 1, v49
    v_add_u32 v46, 4, v46
    v_cndmask_b32 v47, v47, v46, vcc
    v_lshlrev_b32 v47, 7, v47
    v_lshl_add_u32 v47, v48, 2, v47
    v_cmp_gt_u32 vcc, 57, v0
    v_add_u32 v47, 110628, v47
    s_lshl_b32 s42, s44, 12
    v_cndmask_b32 v38, -16, v47, vcc
    v_lshl_add_u32 v43, v0, 4, s42
    s_lshl_b32 s42, s44, 11
    s_add_u32 s42, s42, 8192
    v_lshl_add_u32 v44, v0, 4, s42
    s_mul_i32 s42, s44, 36864
    v_add_u32 v250, s42, v26
    v_add_u32 v251, 18432, v250
    s_mul_i32 s42, s44, 18432
    s_add_u32 s42, s42, 73728
    v_add_u32 v252, s42, v26
    s_lshl_b32 s42, s31, 1
    s_add_u32 s42, s42, s44
    s_lshl_b32 s42, s42, 2
    s_add_u32 s42, s42, 111488
    v_lshl_add_u32 v253, v0, 20, s42
    v_and_b32 v254, 31, v0
    v_lshlrev_b32 v254, 2, v254
    v_add_u32 v254, 111488, v254
    s_and_b32 s44, s32, 1
    s_mul_i32 s36, s44, 18432
    s_lshl_b32 s37, s44, 10
    s_getpc_b64 s[60:61]
    s_lshl_b32 s41, s44, 6
    s_add_u32 s41, s41, 163648
    s_waitcnt vmcnt(0)
    s_mov_b64 exec, 1
    ds_add_u32 v45, v1 offset:4
    s_mov_b64 exec, -1
    s_mov_b64 exec, 262143
    buffer_load_dword v60, v38, s[20:23], 0 offen sc1
    s_mov_b64 exec, -1
    s_mov_b32 s58, 262143
    s_mov_b32 s59, 0
    s_waitcnt vmcnt(0)
    v_cmp_ne_u32 vcc, 0, v60
    s_nop 0
    s_andn2_b64 s[58:59], s[58:59], vcc
    s_cbranch_scc1 L_k0r
L_k0d:
    s_add_u32 m0, s36, 43008
    s_mul_i32 s35, s49, 683
    s_lshr_b32 s35, s35, 16
    buffer_load_dwordx4 v250, s[4:7], s35 offen sc1 lds
    s_add_u32 m0, s36, 44032
    s_nop 0
    buffer_load_dwordx4 v251, s[4:7], s35 offen sc1 lds
    s_add_u32 m0, s36, 45056
    s_mul_i32 s35, s50, 683
    s_lshr_b32 s35, s35, 16
    buffer_load_dwordx4 v250, s[4:7], s35 offen sc1 lds
    s_add_u32 m0, s36, 46080
    s_nop 0
    buffer_load_dwordx4 v251, s[4:7], s35 offen sc1 lds
    s_add_u32 m0, s41, 4
    s_mov_b64 exec, 1
    global_load_lds_dword v0, s[60:61]
    s_mov_b64 exec, -1
    s_add_u32 m0, s36, 47104
    s_mul_i32 s35, s51, 683
    s_lshr_b32 s35, s35, 16
    buffer_load_dwordx4 v250, s[4:7], s35 offen sc1 lds
    s_add_u32 m0, s36, 48128
    s_nop 0
    buffer_load_dwordx4 v251, s[4:7], s35 offen sc1 lds
    s_add_u32 m0, s36, 49152
    s_mul_i32 s35, s52, 683
    s_lshr_b32 s35, s35, 16
    buffer_load_dwordx4 v250, s[4:7], s35 offen sc1 lds
    s_mov_b32 exec_lo, 133955584
    s_mov_b32 exec_hi, 0
    buffer_load_dword v61, v38, s[20:23], 0 offen sc1
    s_mov_b64 exec, -1
    s_add_u32 m0, s36, 50176
    s_nop 0
    buffer_load_dwordx4 v251, s[4:7], s35 offen sc1 lds
    s_add_u32 m0, s41, 8
    s_mov_b64 exec, 1
    global_load_lds_dword v0, s[60:61]
    s_mov_b64 exec, -1
    s_add_u32 m0, s36, 51200
    s_mul_i32 s35, s53, 683
    s_lshr_b32 s35, s35, 16
    buffer_load_dwordx4 v250, s[4:7], s35 offen sc1 lds
    s_add_u32 m0, s36, 52224
    s_nop 0
    buffer_load_dwordx4 v251, s[4:7], s35 offen sc1 lds
    s_add_u32 m0, s36, 53248
    s_mul_i32 s35, s54, 683
    s_lshr_b32 s35, s35, 16
    buffer_load_dwordx4 v250, s[4:7], s35 offen sc1 lds
    s_add_u32 m0, s36, 54272
    s_nop 0
    buffer_load_dwordx4 v251, s[4:7], s35 offen sc1 lds
    s_add_u32 m0, s41, 12
    s_mov_b64 exec, 1
    global_load_lds_dword v0, s[60:61]
    s_mov_b64 exec, -1
    s_add_u32 m0, s37, 73728
    s_mul_i32 s35, s55, 683
    s_lshr_b32 s35, s35, 16
    buffer_load_dwordx4 v250, s[4:7], s35 offen sc1 lds
    s_add_u32 m0, s37, 75776
    s_nop 0
    buffer_load_dwordx4 v251, s[4:7], s35 offen sc1 lds
    s_add_u32 m0, s37, 77824
    s_mul_i32 s35, s56, 683
    s_lshr_b32 s35, s35, 16
    buffer_load_dwordx4 v250, s[4:7], s35 offen sc1 lds
    s_barrier
    s_add_u32 m0, s37, 79872
    s_nop 0
    buffer_load_dwordx4 v251, s[4:7], s35 offen sc1 lds
    s_add_u32 m0, s41, 16
    s_mov_b64 exec, 1
    global_load_lds_dword v0, s[60:61]
    s_mov_b64 exec, -1
    s_mov_b32 exec_lo, 4160749568
    s_mov_b32 exec_hi, 8191
    buffer_load_dword v62, v38, s[20:23], 0 offen sc1
    s_mov_b64 exec, -1
    s_mov_b32 s58, 133955584
    s_mov_b32 s59, 0
    s_waitcnt vmcnt(13)
    v_cmp_ne_u32 vcc, 0, v61
    s_nop 0
    s_andn2_b64 s[58:59], s[58:59], vcc
    s_cbranch_scc1 L_k1r
L_k1d:
    s_add_u32 m0, s37, 81920
    s_mul_i32 s35, s49, 683
    s_lshr_b32 s35, s35, 16
    buffer_load_dwordx4 v252, s[4:7], s35 offen sc1 lds
    s_add_u32 m0, s37, 83968
    s_mul_i32 s35, s50, 683
    s_lshr_b32 s35, s35, 16
    buffer_load_dwordx4 v252, s[4:7], s35 offen sc1 lds
    s_add_u32 m0, s37, 86016
    s_mul_i32 s35, s51, 683
    s_lshr_b32 s35, s35, 16
    buffer_load_dwordx4 v252, s[4:7], s35 offen sc1 lds
    s_add_u32 m0, s37, 0
    s_mul_i32 s35, s52, 683
    s_lshr_b32 s35, s35, 16
    buffer_load_dwordx4 v252, s[4:7], s35 offen sc1 lds
    s_add_u32 m0, s41, 20
    s_mov_b64 exec, 1
    global_load_lds_dword v0, s[60:61]
    s_mov_b64 exec, -1
    s_add_u32 m0, s37, 2048
    s_mul_i32 s35, s53, 683
    s_lshr_b32 s35, s35, 16
    buffer_load_dwordx4 v252, s[4:7], s35 offen sc1 lds
    s_add_u32 m0, s37, 4096
    s_mul_i32 s35, s54, 683
    s_lshr_b32 s35, s35, 16
    buffer_load_dwordx4 v252, s[4:7], s35 offen sc1 lds
    s_add_u32 m0, s37, 6144
    s_mul_i32 s35, s55, 683
    s_lshr_b32 s35, s35, 16
    buffer_load_dwordx4 v252, s[4:7], s35 offen sc1 lds
    s_add_u32 m0, s37, 8192
    s_mul_i32 s35, s56, 683
    s_lshr_b32 s35, s35, 16
    buffer_load_dwordx4 v252, s[4:7], s35 offen sc1 lds
    s_add_u32 m0, s41, 24
    s_mov_b64 exec, 1
    global_load_lds_dword v0, s[60:61]
    s_mov_b64 exec, -1
    s_mov_b32 s58, 4160749568
    s_mov_b32 s59, 8191
    s_waitcnt vmcnt(10)
    v_cmp_ne_u32 vcc, 0, v62
    s_nop 0
    s_andn2_b64 s[58:59], s[58:59], vcc
    s_cbranch_scc1 L_k2r
L_k2d:
    s_add_u32 m0, s37, 10240
    s_mul_i32 s35, s49, 683
    s_lshr_b32 s35, s35, 16
    s_add_u32 s35, s35, 110592
    buffer_load_dwordx4 v250, s[4:7], s35 offen sc1 lds
    s_add_u32 m0, s37, 12288
    s_nop 0
    buffer_load_dwordx4 v251, s[4:7], s35 offen sc1 lds
    s_add_u32 m0, s37, 14336
    s_mul_i32 s35, s50, 683
    s_lshr_b32 s35, s35, 16
    s_add_u32 s35, s35, 110592
    buffer_load_dwordx4 v250, s[4:7], s35 offen sc1 lds
    s_add_u32 m0, s37, 16384
    s_nop 0
    buffer_load_dwordx4 v251, s[4:7], s35 offen sc1 lds
    s_add_u32 m0, s41, 28
    s_mov_b64 exec, 1
    global_load_lds_dword v0, s[60:61]
    s_mov_b64 exec, -1
    s_add_u32 m0, s37, 18432
    s_mul_i32 s35, s51, 683
    s_lshr_b32 s35, s35, 16
    s_add_u32 s35, s35, 110592
    buffer_load_dwordx4 v250, s[4:7], s35 offen sc1 lds
    s_add_u32 m0, s37, 20480
    s_nop 0
    buffer_load_dwordx4 v251, s[4:7], s35 offen sc1 lds
    s_add_u32 m0, s37, 22528
    s_mul_i32 s35, s52, 683
    s_lshr_b32 s35, s35, 16
    s_add_u32 s35, s35, 110592
    buffer_load_dwordx4 v250, s[4:7], s35 offen sc1 lds
    s_add_u32 m0, s37, 24576
    s_nop 0
    buffer_load_dwordx4 v251, s[4:7], s35 offen sc1 lds
    s_add_u32 m0, s41, 32
    s_mov_b64 exec, 1
    global_load_lds_dword v0, s[60:61]
    s_mov_b64 exec, -1
    s_mov_b32 exec_lo, 0
    s_mov_b32 exec_hi, 4186112
    buffer_load_dword v63, v38, s[20:23], 0 offen sc1
    s_mov_b64 exec, -1
    s_add_u32 m0, s37, 26624
    s_mul_i32 s35, s53, 683
    s_lshr_b32 s35, s35, 16
    s_add_u32 s35, s35, 110592
    buffer_load_dwordx4 v250, s[4:7], s35 offen sc1 lds
    s_add_u32 m0, s37, 28672
    s_nop 0
    buffer_load_dwordx4 v251, s[4:7], s35 offen sc1 lds
    s_add_u32 m0, s37, 30720
    s_mul_i32 s35, s54, 683
    s_lshr_b32 s35, s35, 16
    s_add_u32 s35, s35, 110592
    buffer_load_dwordx4 v250, s[4:7], s35 offen sc1 lds
    s_add_u32 m0, s37, 32768
    s_nop 0
    buffer_load_dwordx4 v251, s[4:7], s35 offen sc1 lds
    s_add_u32 m0, s41, 36
    s_mov_b64 exec, 1
    global_load_lds_dword v0, s[60:61]
    s_mov_b64 exec, -1
    s_add_u32 m0, s37, 34816
    s_mul_i32 s35, s55, 683
    s_lshr_b32 s35, s35, 16
    s_add_u32 s35, s35, 110592
    buffer_load_dwordx4 v250, s[4:7], s35 offen sc1 lds
    s_add_u32 m0, s37, 89088
    s_nop 0
    buffer_load_dwordx4 v251, s[4:7], s35 offen sc1 lds
    s_add_u32 m0, s37, 91136
    s_mul_i32 s35, s56, 683
    s_lshr_b32 s35, s35, 16
    s_add_u32 s35, s35, 110592
    buffer_load_dwordx4 v250, s[4:7], s35 offen sc1 lds
    s_add_u32 m0, s37, 93184
    s_nop 0
    buffer_load_dwordx4 v251, s[4:7], s35 offen sc1 lds
    s_add_u32 m0, s41, 40
    s_mov_b64 exec, 1
    global_load_lds_dword v0, s[60:61]
    s_mov_b64 exec, -1
    s_mov_b32 s58, 0
    s_mov_b32 s59, 4186112
    s_waitcnt vmcnt(10)
    v_cmp_ne_u32 vcc, 0, v63
    s_nop 0
    s_andn2_b64 s[58:59], s[58:59], vcc
    s_cbranch_scc1 L_k3r
L_k3d:
    s_add_u32 m0, s37, 94208
    s_nop 0
    buffer_load_dwordx4 v44, s[64:67], s49 offen offset:1024 sc1 lds
    s_add_u32 m0, s37, 98304
    s_nop 0
    buffer_load_dwordx4 v44, s[64:67], s50 offen offset:1024 sc1 lds
    s_add_u32 m0, s37, 100352
    s_nop 0
    buffer_load_dwordx4 v44, s[64:67], s51 offen offset:1024 sc1 lds
    s_add_u32 m0, s37, 106496
    s_nop 0
    buffer_load_dwordx4 v44, s[64:67], s52 offen offset:1024 sc1 lds
    s_add_u32 m0, s41, 44
    s_mov_b64 exec, 1
    global_load_lds_dword v0, s[60:61]
    s_mov_b64 exec, -1
    s_add_u32 m0, s37, 108544
    s_nop 0
    buffer_load_dwordx4 v44, s[64:67], s53 offen offset:1024 sc1 lds
    s_add_u32 m0, s37, 114688
    s_nop 0
    buffer_load_dwordx4 v44, s[64:67], s54 offen offset:1024 sc1 lds
    s_add_u32 m0, s37, 116736
    s_nop 0
    buffer_load_dwordx4 v44, s[64:67], s55 offen offset:1024 sc1 lds
    s_add_u32 m0, s37, 122880
    s_nop 0
    buffer_load_dwordx4 v44, s[64:67], s56 offen offset:1024 sc1 lds
    s_add_u32 m0, s41, 48
    s_mov_b64 exec, 1
    global_load_lds_dword v0, s[60:61]
    s_mov_b64 exec, -1
    s_mov_b64 exec, 1
    s_waitcnt vmcnt(11)
    buffer_store_dword v1, v253, s[20:23], 0 offen
    s_mov_b64 exec, -1
    s_waitcnt vmcnt(0)
    s_branch L_fin
L_hs1:
    s_add_u32 s40, s40, 1
    s_cmp_ge_u32 s40, 0x40000
    s_cbranch_scc1 L_hs1d
    s_sleep 2
    s_load_dword s41, s[24:25], s39 glc
    s_branch L_hs1c
L_hs3:
    s_add_u32 s40, s40, 1
    s_cmp_ge_u32 s40, 0x40000
    s_cbranch_scc1 L_hs3b
    s_sleep 2
    s_load_dword s41, s[20:21], 111360 glc
    s_branch L_hs3c
L_attnDq:
    s_load_dword s39, s[20:21], 111360 glc
    s_waitcnt lgkmcnt(0)
    s_cmp_eq_u32 s39, s3
    s_cbranch_scc1 L_attnDf
    s_add_u32 s64, s64, 4194304
    s_addc_u32 s65, s65, 0
    s_add_u32 s4, s26, 8388608
    s_addc_u32 s5, s27, 0
    s_mov_b32 s62, 0
    s_branch L_attnDs
L_k0r:
    s_add_u32 s40, s40, 1
    s_cmp_ge_u32 s40, 0x40000
    s_cbranch_scc1 L_k0d
    s_mov_b64 exec, s[58:59]
    buffer_load_dword v60, v38, s[20:23], 0 offen sc1
    s_mov_b64 exec, -1
    s_waitcnt vmcnt(0)
    v_cmp_ne_u32 vcc, 0, v60
    s_nop 0
    s_andn2_b64 s[58:59], s[58:59], vcc
    s_cbranch_scc1 L_k0r
    s_branch L_k0d
L_k1r:
    s_add_u32 s40, s40, 1
    s_cmp_ge_u32 s40, 0x40000
    s_cbranch_scc1 L_k1d
    s_mov_b64 exec, s[58:59]
    buffer_load_dword v61, v38, s[20:23], 0 offen sc1
    s_mov_b64 exec, -1
    s_waitcnt vmcnt(0)
    v_cmp_ne_u32 vcc, 0, v61
    s_nop 0
    s_andn2_b64 s[58:59], s[58:59], vcc
    s_cbranch_scc1 L_k1r
    s_branch L_k1d
L_k2r:
    s_add_u32 s40, s40, 1
    s_cmp_ge_u32 s40, 0x40000
    s_cbranch_scc1 L_k2d
    s_mov_b64 exec, s[58:59]
    buffer_load_dword v62, v38, s[20:23], 0 offen sc1
    s_mov_b64 exec, -1
    s_waitcnt vmcnt(0)
    v_cmp_ne_u32 vcc, 0, v62
    s_nop 0
    s_andn2_b64 s[58:59], s[58:59], vcc
    s_cbranch_scc1 L_k2r
    s_branch L_k2d
L_k3r:
    s_add_u32 s40, s40, 1
    s_cmp_ge_u32 s40, 0x40000
    s_cbranch_scc1 L_k3d
    s_mov_b64 exec, s[58:59]
    buffer_load_dword v63, v38, s[20:23], 0 offen sc1
    s_mov_b64 exec, -1
    s_waitcnt vmcnt(0)
    v_cmp_ne_u32 vcc, 0, v63
    s_nop 0
    s_andn2_b64 s[58:59], s[58:59], vcc
    s_cbranch_scc1 L_k3r
    s_branch L_k3d
L_help:
    s_cmp_ge_u32 s2, 256
    s_cbranch_scc1 L_end
    v_and_b32 v0, 63, v0
    s_sub_u32 s42, s29, 27
    s_lshl_b32 s42, s42, 6
    v_add_u32 v2, s42, v0
    s_lshr_b32 s42, s28, 1
    s_mul_i32 s42, s42, 510
    s_and_b32 s43, s28, 1
    s_add_u32 s42, s42, s43
    v_cmp_gt_u32 vcc, 262, v2
    v_lshl_add_u32 v2, v2, 1, s42
    v_mul_u32_u24 v2, 1152, v2
    s_add_u32 s43, s28, s32
    s_add_u32 s43, s43, 1
    s_sub_u32 s44, s43, 9
    s_min_u32 s43, s43, s44
    s_lshl_b32 s43, s43, 7
    v_bfrev_b32 v3, 2
    v_cndmask_b32 v2, v3, v2, vcc
    s_waitcnt lgkmcnt(0)
    s_lshl_b32 s42, s29, 3
    s_add_u32 s42, s42, s32
    s_cmp_eq_u32 s42, 0xff
    s_cbranch_scc1 L_help3
    buffer_load_dword v10, v2, s[4:7], s43 offen
    s_branch L_help2
L_help2:
    s_mov_b64 s[4:5], s[14:15]
L_help3:
    s_mov_b64 s[16:17], s[14:15]
    s_mov_b32 s14, 663552
    s_mov_b32 s15, 0x20000
    s_mul_i32 s42, s28, 334848
    s_add_u32 s20, s26, s42
    s_addc_u32 s21, s27, 0
    s_mov_b32 s22, 334848
    s_mov_b32 s23, 0x20000
    s_cmp_lg_u32 s29, 31
    s_cbranch_scc1 L_noinit
    s_cmp_lg_u32 s32, 7
    s_cbranch_scc1 L_noinit2
    v_lshlrev_b32 v3, 4, v0
    v_mov_b32 v4, 0
    v_mov_b32 v5, 0
    v_mov_b32 v6, 0
    v_mov_b32 v7, 0
    s_mov_b32 s42, 110592
    buffer_store_dwordx4 v[4:7], v3, s[20:23], s42 offen sc1
    s_mov_b32 s42, 222208
    buffer_store_dwordx4 v[4:7], v3, s[20:23], s42 offen sc1
    s_mov_b32 s42, 333824
    buffer_store_dwordx4 v[4:7], v3, s[20:23], s42 offen sc1
    buffer_load_dword v10, v2, s[4:7], s43 offen
    s_mov_b64 s[4:5], s[16:17]
    s_barrier
    s_lshl_b32 s62, s28, 5
    s_mov_b32 s63, 1
    s_waitcnt vmcnt(1)
    s_atomic_or s63, s[24:25], s62
    s_mov_b32 exec_hi, 0xff00ffff
    s_mov_b32 s42, 110592
    buffer_load_dwordx4 v[4:7], v3, s[20:23], s42 offen sc1
    s_mov_b32 s42, 222208
    buffer_load_dwordx4 v[4:7], v3, s[20:23], s42 offen sc1
    s_mov_b32 s42, 333824
    buffer_load_dwordx4 v[4:7], v3, s[20:23], s42 offen sc1
    s_mov_b64 exec, -1
    s_branch L_noinit
L_noinit2:
    s_lshl_b32 s42, s32, 6
    v_add_u32 v2, s42, v0
    s_mul_i32 s42, s28, 216
    s_add_u32 s42, s42, 13824
    v_cmp_gt_u32 vcc, 216, v2
    v_add_lshl_u32 v8, v2, s42, 7
    s_lshl_b32 s43, s28, 3
    v_cndmask_b32 v11, -1, v8, vcc
    v_subrev_u32 v9, 216, v2
    v_cmp_gt_u32 vcc, 232, v9
    v_and_b32 v9, 0x1ff, v9
    s_barrier
    buffer_load_dword v11, v11, s[8:11], 0 offen
    v_lshrrev_b32 v20, 3, v9
    v_mul_u32_u24 v21, 57, v20
    v_lshrrev_b32 v21, 9, v21
    v_mul_u32_u24 v22, 9, v21
    v_sub_u32 v20, v20, v22
    v_sub_u32 v21, v20, v21
    v_add_u32 v21, 8, v21
    v_subrev_u32 v22, 9, v21
    v_min_u32 v21, v21, v22
    v_and_or_b32 v22, v9, 7, s43
    v_lshl_add_u32 v21, v21, 6, v22
    v_mul_u32_u24 v21, 1152, v21
    v_lshl_add_u32 v21, v20, 7, v21
    v_cndmask_b32 v13, -1, v21, vcc
    buffer_load_dword v13, v13, s[12:15], 0 offen
    v_cmp_gt_u32 vcc, 416, v2
    v_add_u32 v9, 232, v2
L_noinit:
    s_sub_u32 s42, s29, 27
    s_mul_i32 s43, s32, 5
    s_add_u32 s45, s42, s43
    s_lshl_b32 s42, s45, 6
    v_add_u32 v2, s42, v0
    s_waitcnt vmcnt(0)
    s_barrier
    s_mul_i32 s42, s45, 44
    v_add_u32 v30, s42, v0
    v_mul_u32_u24 v31, 2428, v30
    v_lshrrev_b32 v31, 16, v31
    v_mul_u32_u24 v32, 27, v31
    v_sub_u32 v32, v30, v32
    v_cmp_gt_u32 vcc, 44, v0
    v_cmp_gt_u32 s[58:59], 64, v31
    v_mul_u32_u24 v31, 3456, v31
    v_lshl_add_u32 v31, v32, 7, v31
    s_and_b64 vcc, vcc, s[58:59]
    v_bfrev_b32 v33, 2
    v_cndmask_b32 v31, v33, v31, vcc
    v_mov_b32 v32, s28
    s_mov_b32 s44, 221184
    v_add_u32 v33, 8, v32
    v_subrev_u32 v34, 9, v33
    v_min_u32 v33, v33, v34
    v_mad_u32_u24 v33, v33, s44, v31
    buffer_load_dword v14, v33, s[8:11], 0 offen
    s_waitcnt vmcnt(0)
    s_barrier
    s_mul_i32 s42, s45, 11
    s_add_u32 s42, s42, 232
    v_add_u32 v9, s42, v0
    s_sub_i32 s42, 648, s42
    s_min_i32 s42, s42, 11
    v_cmp_gt_i32 vcc, s42, v0
    s_lshl_b32 s43, s28, 3
    v_min_u32 v9, 647, v9
    v_lshrrev_b32 v20, 3, v9
    v_mul_u32_u24 v21, 57, v20
    v_lshrrev_b32 v21, 9, v21
    v_mul_u32_u24 v22, 9, v21
    v_sub_u32 v20, v20, v22
    v_sub_u32 v21, v20, v21
    v_add_u32 v21, 8, v21
    v_subrev_u32 v22, 9, v21
    v_min_u32 v21, v21, v22
    v_and_or_b32 v22, v9, 7, s43
    v_lshl_add_u32 v21, v21, 6, v22
    v_mul_u32_u24 v21, 1152, v21
    v_lshl_add_u32 v21, v20, 7, v21
    v_cndmask_b32 v12, -1, v21, vcc
    buffer_load_dword v12, v12, s[12:15], 0 offen
    s_waitcnt vmcnt(0)
    s_barrier
    v_lshrrev_b32 v8, 4, v2
    v_mul_u32_u24 v9, 57, v8
    v_lshrrev_b32 v9, 9, v9
    v_mad_u32_u24 v8, v8, 12, v9
    v_bfe_u32 v9, v2, 3, 1
    v_lshl_add_u32 v8, v9, 1, v8
    v_add_u32 v8, 9, v8
    v_and_b32 v9, 7, v2
    v_lshl_add_u32 v8, v8, 3, v9
    v_cmp_gt_u32 vcc, 432, v2
    v_lshlrev_b32 v8, 7, v8
    v_sub_u32 v20, 2559, v2
    v_cndmask_b32 v8, -1, v8, vcc
    buffer_load_dword v15, v8, s[20:23], 0 offen
    v_mul_u32_u24 v21, 29128, v20
    v_lshrrev_b32 v21, 18, v21
    v_mul_u32_u24 v22, 9, v21
    v_sub_u32 v22, v20, v22
    v_mul_u32_u24 v23, 820, v21
    v_lshrrev_b32 v23, 16, v23
    v_mad_u32_u24 v21, v23, 5, v21
    s_lshr_b32 s42, s28, 1
    s_mul_i32 s42, s42, 510
    s_and_b32 s43, s28, 1
    s_add_u32 s42, s42, s43
    s_add_u32 s42, s42, 16
    v_cmp_gt_u32 vcc, 2160, v20
    v_lshl_add_u32 v21, v21, 1, s42
    v_mul_u32_u24 v21, 1152, v21
    v_lshl_add_u32 v21, v22, 7, v21
    v_cndmask_b32 v21, -1, v21, vcc
    buffer_load_dword v16, v21, s[4:7], 0 offen
    s_endpgm
    .p2alignl 12, 0xbf810000
    .fill 238, 4, 0xbf810000
L_ool:
    v_and_b32 v0, 63, v0
    v_and_b32 v47, 6, v49
    v_xor_b32 v47, v47, v0
    v_and_b32 v47, 7, v47
    v_lshl_add_u32 v47, v47, 4, s44
    v_mul_u32_u24 v49, 1152, v49
    v_add_u32 v245, v47, v49
    s_mov_b64 s[16:17], s[14:15]
    s_mov_b32 s14, 663552
    s_mov_b32 s15, 0x20000
    s_mov_b32 s18, 2359296
    s_mov_b32 s19, 0x20000
    s_mul_i32 s42, s28, 3
    s_add_u32 s42, s42, s30
    s_mul_i32 s42, s42, 111616
    s_add_u32 s20, s26, s42
    s_addc_u32 s21, s27, 0
    s_mov_b32 s22, 111616
    s_mov_b32 s23, 0x20000
    s_mov_b32 s40, 0
    s_mov_b32 s46, 1051597459
    s_mov_b32 s47, 1051597459
    s_mov_b64 s[64:65], s[20:21]
    s_mov_b32 s66, 110592
    s_mov_b32 s67, 0x20000
    s_mul_i32 s48, s31, 12288
    s_lshl_b32 s57, 5, s31
    s_bfe_u32 s57, s57, 0x90001
    s_getreg_b32 s42, hwreg(HW_REG_XCC_ID, 0, 4)
    s_mul_i32 s3, s42, s42
    s_lshl_b32 s3, s3, 8
    s_add_u32 s3, s3, s42
    s_lshl_b32 s3, s3, 8
    s_add_u32 s3, s3, 1
    s_cmp_eq_u32 s32, 7
    s_cselect_b32 s42, 111360, 2.0
    v_lshl_add_u32 v249, v0, 20, s42
    s_add_u32 s49, s48, 12288
    s_cmp_eq_u32 s49, 110592
    s_cselect_b32 s49, 0, s49
    s_add_u32 s50, s49, 12288
    s_cmp_eq_u32 s50, 110592
    s_cselect_b32 s50, 0, s50
    s_add_u32 s51, s50, 12288
    s_cmp_eq_u32 s51, 110592
    s_cselect_b32 s51, 0, s51
    s_add_u32 s52, s51, 12288
    s_cmp_eq_u32 s52, 110592
    s_cselect_b32 s52, 0, s52
    s_add_u32 s53, s52, 12288
    s_cmp_eq_u32 s53, 110592
    s_cselect_b32 s53, 0, s53
    s_add_u32 s54, s53, 12288
    s_cmp_eq_u32 s54, 110592
    s_cselect_b32 s54, 0, s54
    s_add_u32 s55, s54, 12288
    s_cmp_eq_u32 s55, 110592
    s_cselect_b32 s55, 0, s55
    s_add_u32 s56, s55, 12288
    s_cmp_eq_u32 s56, 110592
    s_cselect_b32 s56, 0, s56
    v_mov_b32 v46, 0xff800000
    v_mov_b32 v47, 0xffff
    v_mov_b32 v1, 1
    v_mov_b32 v6, 0
    v_mov_b32 v8, 0
    s_mov_b32 vcc_lo, 1431983445
    s_mov_b32 vcc_hi, 1521112490
    v_cndmask_b32 v2, v46, 0, vcc
    v_cndmask_b32 v10, 0, v47, vcc
    s_mov_b32 vcc_lo, 2862656170
    s_mov_b32 vcc_hi, 2684398080
    v_cndmask_b32 v3, v46, 0, vcc
    v_cndmask_b32 v11, 0, v47, vcc
    s_mov_b32 vcc_lo, 327680
    s_mov_b32 vcc_hi, 89456725
    s_cmp_eq_u32 s32, 0
    s_cselect_b64 vcc, 0, vcc
    v_cndmask_b32 v7, v46, 0, vcc
    v_cndmask_b32 v12, 0, v47, vcc
    s_mov_b32 vcc_lo, 1433032022
    s_mov_b32 vcc_hi, 1789548202
    v_cndmask_b32 v4, v46, 0, vcc
    v_cndmask_b32 v48, 0, v47, vcc
    v_lshl_or_b32 v10, v48, 16, v10
    s_mov_b32 vcc_lo, 2860559016
    s_mov_b32 vcc_hi, 2147526656
    v_cndmask_b32 v5, v46, 0, vcc
    v_cndmask_b32 v48, 0, v47, vcc
    v_lshl_or_b32 v11, v48, 16, v11
    s_branch L_oolb
L_comp:
    v_and_b32 v0, 63, v0
    v_and_b32 v46, 15, v0
    v_lshrrev_b32 v47, 4, v0
    v_lshrrev_b32 v48, 1, v46
    v_xor_b32 v48, v48, v47
    v_lshlrev_b32 v48, 4, v48
    s_and_b32 s42, s30, 1
    s_lshl_b32 s42, s42, 6
    v_xor_b32 v48, s42, v48
    v_lshl_add_u32 v52, v46, 7, v48
    v_xor_b32 v53, 64, v52
    v_add_u32 v54, 73728, v52
    v_add_u32 v55, 73728, v53
    v_bfe_u32 v46, v0, 2, 2
    v_lshl_add_u32 v48, v47, 3, v46
    v_lshlrev_b32 v48, 7, v48
    v_bfe_u32 v46, v0, 3, 2
    v_xor_b32 v46, s32, v46
    v_lshl_add_u32 v48, v46, 5, v48
    v_and_b32 v46, 3, v0
    v_lshl_add_u32 v48, v46, 3, v48
    v_add_u32 v56, 12288, v48
    v_add_u32 v57, 73728, v56
    s_lshl_b32 s42, s32, 9
    s_add_u32 s42, s42, 0
    v_lshl_add_u32 v58, v0, 3, s42
    s_and_b32 s43, s32, 1
    s_mul_i32 s43, s43, 504
    s_sub_u32 s42, s42, s43
    v_lshl_add_u32 v59, v0, 4, s42
    s_lshl_b32 s42, s32, 3
    s_lshr_b32 s42, 0x81010080, s42
    s_and_b32 s42, s42, 0xff
    s_lshl_b32 s42, s42, 3
    s_add_u32 s42, s42, 0
    v_lshl_add_u32 v58, v0, 4, s42
    s_waitcnt lgkmcnt(0)
    s_mov_b64 s[16:17], s[14:15]
    s_mov_b32 s14, 663552
    s_mov_b32 s15, 0x20000
    s_mov_b32 s18, 2359296
    s_mov_b32 s19, 0x20000
    s_mul_i32 s42, s28, 3
    s_add_u32 s42, s42, s30
    s_mul_i32 s42, s42, 111616
    s_add_u32 s20, s26, s42
    s_addc_u32 s21, s27, 0
    s_mov_b32 s22, 111616
    s_mov_b32 s23, 0x20000
    s_mov_b32 s40, 0
    s_mov_b32 s46, 1051597459
    s_mov_b32 s47, 1051597459
    s_mov_b64 s[64:65], s[20:21]
    s_mov_b32 s66, 110592
    s_mov_b32 s67, 0x20000
    s_mul_i32 s48, s31, 12288
    s_lshl_b32 s57, 5, s31
    s_bfe_u32 s57, s57, 0x90001
    s_getreg_b32 s42, hwreg(HW_REG_XCC_ID, 0, 4)
    s_mul_i32 s3, s42, s42
    s_lshl_b32 s3, s3, 8
    s_add_u32 s3, s3, s42
    s_lshl_b32 s3, s3, 8
    s_add_u32 s3, s3, 1
    v_mov_b32 v46, 0xff800000
    v_mov_b32 v47, 0xffff
    v_mov_b32 v1, 1
    v_mov_b32 v6, 0
    v_mov_b32 v8, 0
    s_mov_b32 vcc_lo, 1431983445
    s_mov_b32 vcc_hi, 1521112490
    v_cndmask_b32 v2, v46, 0, vcc
    v_cndmask_b32 v10, 0, v47, vcc
    s_mov_b32 vcc_lo, 2862656170
    s_mov_b32 vcc_hi, 2684398080
    v_cndmask_b32 v3, v46, 0, vcc
    v_cndmask_b32 v11, 0, v47, vcc
    s_mov_b32 vcc_lo, 327680
    s_mov_b32 vcc_hi, 89456725
    s_cmp_eq_u32 s32, 0
    s_cselect_b64 vcc, 0, vcc
    v_cndmask_b32 v7, v46, 0, vcc
    v_cndmask_b32 v12, 0, v47, vcc
    s_mov_b32 vcc_lo, 1433032022
    s_mov_b32 vcc_hi, 1789548202
    v_cndmask_b32 v4, v46, 0, vcc
    v_cndmask_b32 v48, 0, v47, vcc
    v_lshl_or_b32 v10, v48, 16, v10
    s_mov_b32 vcc_lo, 2860559016
    s_mov_b32 vcc_hi, 2147526656
    v_cndmask_b32 v5, v46, 0, vcc
    v_cndmask_b32 v48, 0, v47, vcc
    v_lshl_or_b32 v11, v48, 16, v11
    s_mov_b32 vcc_lo, 1376257
    s_mov_b32 vcc_hi, 357892437
    s_cmp_eq_u32 s32, 0
    s_cselect_b64 vcc, 0, vcc
    v_cndmask_b32 v9, v46, 0, vcc
    v_cndmask_b32 v48, 0, v47, vcc
    v_lshl_or_b32 v12, v48, 16, v12
    v_lshrrev_b32 v46, 4, v0
    v_lshlrev_b32 v47, 1, v46
    v_bfe_u32 v48, v0, 1, 3
    s_mul_i32 s42, s31, 228
    s_lshr_b32 s42, s42, 9
    s_mul_i32 s42, s42, 9
    s_lshl_b32 s43, s31, 2
    s_sub_u32 s43, s43, s42
    v_subrev_u32 v49, s43, v47
    v_ashrrev_i32 v13, 31, v49
    v_add_u32 v49, 1, v49
    v_ashrrev_i32 v14, 31, v49
    v_subrev_u32 v49, s43, v48
    v_ashrrev_i32 v21, 31, v49
    s_add_u32 s43, s43, 1
    s_cmp_eq_u32 s43, 9
    s_cselect_b32 s43, 0, s43
    v_subrev_u32 v49, s43, v47
    v_ashrrev_i32 v15, 31, v49
    v_add_u32 v49, 1, v49
    v_ashrrev_i32 v16, 31, v49
    v_subrev_u32 v49, s43, v48
    v_ashrrev_i32 v22, 31, v49
    s_add_u32 s43, s43, 1
    s_cmp_eq_u32 s43, 9
    s_cselect_b32 s43, 0, s43
    v_subrev_u32 v49, s43, v47
    v_ashrrev_i32 v17, 31, v49
    v_add_u32 v49, 1, v49
    v_ashrrev_i32 v18, 31, v49
    v_subrev_u32 v49, s43, v48
    v_ashrrev_i32 v23, 31, v49
    s_add_u32 s43, s43, 1
    s_cmp_eq_u32 s43, 9
    s_cselect_b32 s43, 0, s43
    v_subrev_u32 v49, s43, v47
    v_ashrrev_i32 v19, 31, v49
    v_add_u32 v49, 1, v49
    v_ashrrev_i32 v20, 31, v49
    v_subrev_u32 v49, s43, v48
    v_ashrrev_i32 v24, 31, v49
    s_mul_i32 s42, s32, 6144
    s_add_u32 s42, s42, 0
    v_lshl_add_u32 v25, v0, 3, s42
    s_sub_u32 s42, s42, 6144
    s_max_i32 s42, s42, 0
    v_lshl_add_u32 v26, v0, 3, s42
    s_lshl_b32 s44, s32, 11
    v_lshl_add_u32 v31, v0, 4, s44
    s_add_u32 s42, s44, s48
    s_add_u32 s42, s42, 1024
    s_add_u32 s42, s34, 112
    s_mul_i32 s42, s42, 1152
    s_mul_i32 s43, s32, 18432
    s_add_u32 s42, s42, s43
    s_lshl_b32 s43, s31, 7
    s_add_u32 s42, s42, s43
    v_mul_u32_u24 v49, 272, v46
    v_add_u32 v49, v49, v0
    s_add_u32 s43, s42, 9088
    s_cmp_eq_u32 s31, 0
    s_cselect_b32 s43, 0x40000000, s43
    s_cselect_b32 s45, 0x40000000, s42
    v_lshl_add_u32 v27, v49, 3, s43
    v_lshl_add_u32 v29, v49, 3, s45
    s_add_u32 s43, s42, 128
    s_add_u32 s45, s42, 9216
    s_cmp_eq_u32 s31, 8
    s_cselect_b32 s43, 0x40000000, s43
    s_cselect_b32 s45, 0x40000000, s45
    v_lshl_add_u32 v28, v49, 3, s43
    v_lshl_add_u32 v30, v49, 3, s45
    s_lshl_b32 s42, s32, 7
    s_add_u32 s42, s42, 110592
    v_and_b32 v47, 15, v0
    v_lshl_add_u32 v33, v47, 2, s42
    s_lshl_b32 s43, s31, 2
    s_add_u32 s42, s42, s43
    v_lshl_add_u32 v32, v0, 20, s42
    s_lshr_b32 s44, s32, 1
    s_and_b32 s45, s32, 1
    s_lshl_b32 s42, s45, 1
    v_lshrrev_b32 v48, 2, v0
    v_lshlrev_b32 v49, 7, v48
    v_bfe_u32 v50, v0, 3, 2
    v_xor_b32 v50, s42, v50
    v_lshl_add_u32 v49, v50, 5, v49
    v_and_b32 v50, 3, v0
    v_lshl_add_u32 v49, v50, 3, v49
    v_add_u32 v34, 89088, v49
    v_xor_b32 v35, 32, v34
    v_add_u32 v36, 32768, v34
    v_add_u32 v37, 32768, v35
    s_waitcnt lgkmcnt(0)
    v_mov_b32 v45, 163584
    s_setprio 1
    s_barrier
    ds_read_b64_tr_b16 v[156:157], v57 offset:0
    ds_read_b64_tr_b16 v[158:159], v57 offset:512
    ds_read_b128 v[132:135], v52 offset:36864
    ds_read_b64_tr_b16 v[160:161], v57 offset:8192
    ds_read_b64_tr_b16 v[162:163], v57 offset:8704
    ds_read_b64_tr_b16 v[164:165], v57 offset:16384
    ds_read_b64_tr_b16 v[166:167], v57 offset:16896
    ds_read_b128 v[136:139], v52 offset:38912
    ds_read_b128 v[140:143], v52 offset:40960
    ds_read_b128 v[144:147], v52 offset:43008
    ds_read_b128 v[148:151], v52 offset:45056
    ds_read_b128 v[152:155], v52 offset:47104
    s_waitcnt lgkmcnt(9)
    v_mfma_f32_16x16x32_bf16 v[60:63], v[156:159], v[132:135], 0
    s_waitcnt lgkmcnt(7)
    v_mfma_f32_16x16x32_bf16 v[84:87], v[160:163], v[132:135], 0
    s_waitcnt lgkmcnt(5)
    v_mfma_f32_16x16x32_bf16 v[108:111], v[132:135], v[164:167], 0
    s_waitcnt lgkmcnt(4)
    v_mfma_f32_16x16x32_bf16 v[64:67], v[156:159], v[136:139], 0
    v_mfma_f32_16x16x32_bf16 v[88:91], v[160:163], v[136:139], 0
    v_mfma_f32_16x16x32_bf16 v[112:115], v[136:139], v[164:167], 0
    s_waitcnt lgkmcnt(3)
    v_mfma_f32_16x16x32_bf16 v[68:71], v[156:159], v[140:143], 0
    v_mfma_f32_16x16x32_bf16 v[92:95], v[160:163], v[140:143], 0
    v_mfma_f32_16x16x32_bf16 v[116:119], v[140:143], v[164:167], 0
    s_waitcnt lgkmcnt(2)
    v_mfma_f32_16x16x32_bf16 v[72:75], v[156:159], v[144:147], 0
    s_waitcnt lgkmcnt(0)
    s_barrier
    ds_read_b64_tr_b16 v[192:193], v57 offset:4096
    ds_read_b64_tr_b16 v[194:195], v57 offset:4608
    v_mfma_f32_16x16x32_bf16 v[96:99], v[160:163], v[144:147], 0
    ds_read_b128 v[168:171], v53 offset:36864
    ds_read_b64_tr_b16 v[196:197], v57 offset:12288
    v_mfma_f32_16x16x32_bf16 v[120:123], v[144:147], v[164:167], 0
    ds_read_b64_tr_b16 v[198:199], v57 offset:12800
    ds_read_b64_tr_b16 v[200:201], v57 offset:20480
    v_mfma_f32_16x16x32_bf16 v[76:79], v[156:159], v[148:151], 0
    ds_read_b64_tr_b16 v[202:203], v57 offset:20992
    ds_read_b128 v[172:175], v53 offset:38912
    v_mfma_f32_16x16x32_bf16 v[100:103], v[160:163], v[148:151], 0
    ds_read_b128 v[176:179], v53 offset:40960
    ds_read_b128 v[180:183], v53 offset:43008
    v_mfma_f32_16x16x32_bf16 v[124:127], v[148:151], v[164:167], 0
    ds_read_b128 v[184:187], v53 offset:45056
    ds_read_b128 v[188:191], v53 offset:47104
    v_mfma_f32_16x16x32_bf16 v[80:83], v[156:159], v[152:155], 0
    v_mfma_f32_16x16x32_bf16 v[104:107], v[160:163], v[152:155], 0
    v_mfma_f32_16x16x32_bf16 v[128:131], v[152:155], v[164:167], 0
    s_waitcnt lgkmcnt(9)
    v_mfma_f32_16x16x32_bf16 v[60:63], v[192:195], v[168:171], v[60:63]
    s_waitcnt lgkmcnt(7)
    v_mfma_f32_16x16x32_bf16 v[84:87], v[196:199], v[168:171], v[84:87]
    s_waitcnt lgkmcnt(5)
    v_mfma_f32_16x16x32_bf16 v[108:111], v[168:171], v[200:203], v[108:111]
    s_waitcnt lgkmcnt(4)
    v_mfma_f32_16x16x32_bf16 v[64:67], v[192:195], v[172:175], v[64:67]
    v_mfma_f32_16x16x32_bf16 v[88:91], v[196:199], v[172:175], v[88:91]
    v_mfma_f32_16x16x32_bf16 v[112:115], v[172:175], v[200:203], v[112:115]
    s_waitcnt lgkmcnt(3)
    v_mfma_f32_16x16x32_bf16 v[68:71], v[192:195], v[176:179], v[68:71]
    v_mfma_f32_16x16x32_bf16 v[92:95], v[196:199], v[176:179], v[92:95]
    v_mfma_f32_16x16x32_bf16 v[116:119], v[176:179], v[200:203], v[116:119]
    s_waitcnt lgkmcnt(2)
    v_mfma_f32_16x16x32_bf16 v[72:75], v[192:195], v[180:183], v[72:75]
    s_waitcnt lgkmcnt(0)
    s_mul_i32 s42, s44, 18432
    s_add_u32 s42, s42, 36864
    v_lshl_add_u32 v43, v0, 4, s42
    s_lshl_b32 s43, s44, 10
    s_add_u32 s43, s43, 0
    v_lshl_add_u32 v44, v0, 4, s43
    s_lshl_b32 s42, s32, 10
    s_add_u32 s42, s42, 132096
    v_lshrrev_b32 v49, 4, v0
    v_xor_b32 v49, v49, v0
    v_and_b32 v49, 6, v49
    v_and_b32 v46, 1, v46
    v_or_b32 v49, v49, v46
    v_lshl_add_u32 v49, v49, 3, s42
    v_lshl_add_u32 v38, v47, 6, v49
    v_lshrrev_b32 v49, 3, v0
    v_xor_b32 v46, v49, v0
    v_and_b32 v46, 3, v46
    v_lshl_add_u32 v46, v46, 4, s42
    v_lshl_add_u32 v39, v48, 6, v46
    v_and_b32 v46, 4, v0
    v_lshl_add_u32 v49, v46, 1, v49
    s_lshl_b32 s42, s31, 7
    s_lshl_b32 s43, s45, 6
    s_add_u32 s42, s42, s43
    v_lshl_add_u32 v50, v50, 4, s42
    s_cmp_eq_u32 s33, 0
    s_cselect_b32 s42, 0, 7
    s_sub_u32 s43, 92, s42
    v_bfrev_b32 v48, 1
    s_lshl_b32 s45, s44, 5
    v_add_u32 v46, s45, v49
    v_subrev_u32 v47, s42, v46
    v_cmp_gt_u32 vcc, s43, v47
    v_lshl_add_u32 v46, v46, 1, s34
    v_mul_u32_u24 v46, 1152, v46
    v_add_u32 v46, v46, v50
    v_cndmask_b32 v40, v48, v46, vcc
    s_add_u32 s45, s45, 16
    v_add_u32 v46, s45, v49
    v_subrev_u32 v47, s42, v46
    v_cmp_gt_u32 vcc, s43, v47
    v_lshl_add_u32 v46, v46, 1, s34
    v_mul_u32_u24 v46, 1152, v46
    v_add_u32 v46, v46, v50
    v_cndmask_b32 v41, v48, v46, vcc
    s_lshl_b32 s45, s44, 4
    s_add_u32 s45, s45, 64
    v_add_u32 v46, s45, v49
    v_subrev_u32 v47, s42, v46
    v_cmp_gt_u32 vcc, s43, v47
    v_lshl_add_u32 v46, v46, 1, s34
    v_mul_u32_u24 v46, 1152, v46
    v_add_u32 v46, v46, v50
    v_cndmask_b32 v42, v48, v46, vcc
    s_and_b32 s42, s32, 1
    s_lshl_b32 s42, s42, 10
    v_add_u32 v51, s42, v43
    v_add_u32 v47, 73728, v44
    v_xor_b32 v48, 32, v38
    s_lshr_b32 s42, s32, 1
    s_lshl_b32 s42, s42, 6
    s_add_u32 s41, s42, 163584
    v_lshl_add_u32 v49, v0, 3, v25
    v_lshl_add_u32 v50, v0, 3, v26
    v_lshrrev_b32 v46, 3, v0
    v_mul_u32_u24 v46, 2304, v46
    v_and_b32 v26, 7, v0
    v_lshl_add_u32 v26, v26, 4, v46
    s_add_u32 s42, s34, 16
    s_mul_i32 s42, s42, 1152
    v_add_u32 v26, s42, v26
    s_mul_i32 s42, s32, 18432
    s_lshl_b32 s43, s31, 7
    s_add_u32 s42, s42, s43
    v_add_u32 v25, s42, v26
    s_mov_b64 s[4:5], s[16:17]
    v_add_u32 v26, 110592, v25
    s_mul_i32 s3, s3, 9
    v_mov_b32 v248, -1
    v_mov_b32 v249, -1
    v_mov_b32 v250, -1
    v_mov_b32 v251, -1
    buffer_store_dwordx4 v[248:251], v26, s[4:7], 0 offen
    s_add_u32 s42, s48, 8192
    s_cmp_ge_u32 s32, 2
    s_cbranch_scc1 L_nosent
    buffer_store_dwordx4 v[248:251], v31, s[64:67], s42 offen offset:1024
L_nosent:
    v_and_b32 v31, 31, v0
    v_lshlrev_b32 v31, 2, v31
    v_add_u32 v31, 111488, v31
    s_barrier
    ds_read_b64_tr_b16 v[156:157], v56 offset:0
    ds_read_b64_tr_b16 v[158:159], v56 offset:512
    v_mfma_f32_16x16x32_bf16 v[96:99], v[196:199], v[180:183], v[96:99]
    ds_read_b128 v[132:135], v54 offset:0
    ds_read_b64_tr_b16 v[160:161], v56 offset:8192
    v_mfma_f32_16x16x32_bf16 v[120:123], v[180:183], v[200:203], v[120:123]
    ds_read_b64_tr_b16 v[162:163], v56 offset:8704
    ds_read_b64_tr_b16 v[164:165], v56 offset:16384
    v_mfma_f32_16x16x32_bf16 v[76:79], v[192:195], v[184:187], v[76:79]
    ds_read_b64_tr_b16 v[166:167], v56 offset:16896
    ds_read_b128 v[136:139], v54 offset:2048
    v_mfma_f32_16x16x32_bf16 v[100:103], v[196:199], v[184:187], v[100:103]
    ds_read_b128 v[140:143], v54 offset:4096
    ds_read_b128 v[144:147], v54 offset:6144
    v_mfma_f32_16x16x32_bf16 v[124:127], v[184:187], v[200:203], v[124:127]
    ds_read_b128 v[148:151], v54 offset:8192
    ds_read_b128 v[152:155], v54 offset:10240
    v_mfma_f32_16x16x32_bf16 v[80:83], v[192:195], v[188:191], v[80:83]
    v_mfma_f32_16x16x32_bf16 v[104:107], v[196:199], v[188:191], v[104:107]
    v_mfma_f32_16x16x32_bf16 v[128:131], v[188:191], v[200:203], v[128:131]
    s_waitcnt lgkmcnt(9)
    v_mfma_f32_16x16x32_bf16 v[60:63], v[156:159], v[132:135], v[60:63]
    ds_read_b64_tr_b16 v[192:193], v56 offset:4096
    s_waitcnt lgkmcnt(8)
    v_mfma_f32_16x16x32_bf16 v[84:87], v[160:163], v[132:135], v[84:87]
    ds_read_b64_tr_b16 v[194:195], v56 offset:4608
    s_waitcnt lgkmcnt(7)
    v_mfma_f32_16x16x32_bf16 v[108:111], v[132:135], v[164:167], v[108:111]
    ds_read_b128 v[168:171], v55 offset:0
    s_waitcnt lgkmcnt(7)
    v_mfma_f32_16x16x32_bf16 v[64:67], v[156:159], v[136:139], v[64:67]
    ds_read_b64_tr_b16 v[196:197], v56 offset:12288
    v_mfma_f32_16x16x32_bf16 v[88:91], v[160:163], v[136:139], v[88:91]
    ds_read_b64_tr_b16 v[198:199], v56 offset:12800
    v_mfma_f32_16x16x32_bf16 v[112:115], v[136:139], v[164:167], v[112:115]
    s_waitcnt lgkmcnt(5)
    ds_read_b64_tr_b16 v[200:201], v56 offset:20480
    v_mfma_f32_16x16x32_bf16 v[68:71], v[156:159], v[140:143], v[68:71]
    ds_read_b64_tr_b16 v[202:203], v56 offset:20992
    v_mfma_f32_16x16x32_bf16 v[92:95], v[160:163], v[140:143], v[92:95]
    ds_read_b128 v[172:175], v55 offset:2048
    v_mfma_f32_16x16x32_bf16 v[116:119], v[140:143], v[164:167], v[116:119]
    ds_read_b128 v[176:179], v55 offset:4096
    v_mfma_f32_16x16x32_bf16 v[72:75], v[156:159], v[144:147], v[72:75]
    ds_read_b128 v[180:183], v55 offset:6144
    v_mfma_f32_16x16x32_bf16 v[96:99], v[160:163], v[144:147], v[96:99]
    ds_read_b128 v[184:187], v55 offset:8192
    v_mfma_f32_16x16x32_bf16 v[120:123], v[144:147], v[164:167], v[120:123]
    ds_read_b128 v[188:191], v55 offset:10240
    v_mfma_f32_16x16x32_bf16 v[76:79], v[156:159], v[148:151], v[76:79]
    v_mfma_f32_16x16x32_bf16 v[100:103], v[160:163], v[148:151], v[100:103]
    v_mfma_f32_16x16x32_bf16 v[124:127], v[148:151], v[164:167], v[124:127]
    v_mfma_f32_16x16x32_bf16 v[80:83], v[156:159], v[152:155], v[80:83]
    v_mfma_f32_16x16x32_bf16 v[104:107], v[160:163], v[152:155], v[104:107]
    v_mfma_f32_16x16x32_bf16 v[128:131], v[152:155], v[164:167], v[128:131]
    s_waitcnt lgkmcnt(0)
    v_mfma_f32_16x16x32_bf16 v[60:63], v[192:195], v[168:171], v[60:63]
    v_mfma_f32_16x16x32_bf16 v[84:87], v[196:199], v[168:171], v[84:87]
    v_mfma_f32_16x16x32_bf16 v[108:111], v[168:171], v[200:203], v[108:111]
    v_mfma_f32_16x16x32_bf16 v[64:67], v[192:195], v[172:175], v[64:67]
    v_mfma_f32_16x16x32_bf16 v[88:91], v[196:199], v[172:175], v[88:91]
    v_mfma_f32_16x16x32_bf16 v[112:115], v[172:175], v[200:203], v[112:115]
    v_mfma_f32_16x16x32_bf16 v[68:71], v[192:195], v[176:179], v[68:71]
    v_mfma_f32_16x16x32_bf16 v[92:95], v[196:199], v[176:179], v[92:95]
    v_mfma_f32_16x16x32_bf16 v[116:119], v[176:179], v[200:203], v[116:119]
    v_mfma_f32_16x16x32_bf16 v[72:75], v[192:195], v[180:183], v[72:75]
    s_waitcnt vmcnt(0)
    s_barrier
    ds_read_b64_tr_b16 v[156:157], v56 offset:36864
    ds_read_b64_tr_b16 v[158:159], v56 offset:37376
    v_mfma_f32_16x16x32_bf16 v[96:99], v[196:199], v[180:183], v[96:99]
    ds_read_b128 v[132:135], v54 offset:39936
    ds_read_b64_tr_b16 v[160:161], v56 offset:45056
    v_mfma_f32_16x16x32_bf16 v[120:123], v[180:183], v[200:203], v[120:123]
    ds_read_b64_tr_b16 v[162:163], v56 offset:45568
    ds_read_b64_tr_b16 v[164:165], v56 offset:53248
    v_mfma_f32_16x16x32_bf16 v[76:79], v[192:195], v[184:187], v[76:79]
    ds_read_b64_tr_b16 v[166:167], v56 offset:53760
    ds_read_b128 v[136:139], v54 offset:41984
    v_mfma_f32_16x16x32_bf16 v[100:103], v[196:199], v[184:187], v[100:103]
    ds_read_b128 v[140:143], v54 offset:44032
    ds_read_b128 v[144:147], v54 offset:46080
    v_mfma_f32_16x16x32_bf16 v[124:127], v[184:187], v[200:203], v[124:127]
    ds_read_b128 v[148:151], v54 offset:48128
    ds_read_b128 v[152:155], v54 offset:50176
    v_mfma_f32_16x16x32_bf16 v[80:83], v[192:195], v[188:191], v[80:83]
    v_mfma_f32_16x16x32_bf16 v[104:107], v[196:199], v[188:191], v[104:107]
    v_mfma_f32_16x16x32_bf16 v[128:131], v[188:191], v[200:203], v[128:131]
    s_waitcnt lgkmcnt(9)
    v_mfma_f32_16x16x32_bf16 v[60:63], v[156:159], v[132:135], v[60:63]
    ds_read_b64_tr_b16 v[192:193], v56 offset:40960
    s_waitcnt lgkmcnt(8)
    v_mfma_f32_16x16x32_bf16 v[84:87], v[160:163], v[132:135], v[84:87]
    ds_read_b64_tr_b16 v[194:195], v56 offset:41472
    s_waitcnt lgkmcnt(7)
    v_mfma_f32_16x16x32_bf16 v[108:111], v[132:135], v[164:167], v[108:111]
    ds_read_b128 v[168:171], v55 offset:39936
    s_waitcnt lgkmcnt(7)
    v_mfma_f32_16x16x32_bf16 v[64:67], v[156:159], v[136:139], v[64:67]
    ds_read_b64_tr_b16 v[196:197], v56 offset:49152
    v_mfma_f32_16x16x32_bf16 v[88:91], v[160:163], v[136:139], v[88:91]
    ds_read_b64_tr_b16 v[198:199], v56 offset:49664
    v_mfma_f32_16x16x32_bf16 v[112:115], v[136:139], v[164:167], v[112:115]
    s_waitcnt lgkmcnt(5)
    ds_read_b64_tr_b16 v[200:201], v56 offset:57344
    v_mfma_f32_16x16x32_bf16 v[68:71], v[156:159], v[140:143], v[68:71]
    ds_read_b64_tr_b16 v[202:203], v56 offset:57856
    v_mfma_f32_16x16x32_bf16 v[92:95], v[160:163], v[140:143], v[92:95]
    ds_read_b128 v[172:175], v55 offset:41984
    v_mfma_f32_16x16x32_bf16 v[116:119], v[140:143], v[164:167], v[116:119]
    ds_read_b128 v[176:179], v55 offset:44032
    v_mfma_f32_16x16x32_bf16 v[72:75], v[156:159], v[144:147], v[72:75]
    ds_read_b128 v[180:183], v55 offset:46080
    v_mfma_f32_16x16x32_bf16 v[96:99], v[160:163], v[144:147], v[96:99]
    ds_read_b128 v[184:187], v55 offset:48128
    v_mfma_f32_16x16x32_bf16 v[120:123], v[144:147], v[164:167], v[120:123]
    ds_read_b128 v[188:191], v55 offset:50176
    v_mfma_f32_16x16x32_bf16 v[76:79], v[156:159], v[148:151], v[76:79]
    v_mfma_f32_16x16x32_bf16 v[100:103], v[160:163], v[148:151], v[100:103]
    v_mfma_f32_16x16x32_bf16 v[124:127], v[148:151], v[164:167], v[124:127]
    v_mfma_f32_16x16x32_bf16 v[80:83], v[156:159], v[152:155], v[80:83]
    v_mfma_f32_16x16x32_bf16 v[104:107], v[160:163], v[152:155], v[104:107]
    v_mfma_f32_16x16x32_bf16 v[128:131], v[152:155], v[164:167], v[128:131]
    s_waitcnt lgkmcnt(0)
    v_mfma_f32_16x16x32_bf16 v[60:63], v[192:195], v[168:171], v[60:63]
    v_mfma_f32_16x16x32_bf16 v[84:87], v[196:199], v[168:171], v[84:87]
    v_mfma_f32_16x16x32_bf16 v[108:111], v[168:171], v[200:203], v[108:111]
    v_mfma_f32_16x16x32_bf16 v[64:67], v[192:195], v[172:175], v[64:67]
    v_mfma_f32_16x16x32_bf16 v[88:91], v[196:199], v[172:175], v[88:91]
    v_mfma_f32_16x16x32_bf16 v[112:115], v[172:175], v[200:203], v[112:115]
    v_mfma_f32_16x16x32_bf16 v[68:71], v[192:195], v[176:179], v[68:71]
    v_mfma_f32_16x16x32_bf16 v[92:95], v[196:199], v[176:179], v[92:95]
    v_mfma_f32_16x16x32_bf16 v[116:119], v[176:179], v[200:203], v[116:119]
    v_mfma_f32_16x16x32_bf16 v[72:75], v[192:195], v[180:183], v[72:75]
    s_barrier
    ds_read_b64_tr_b16 v[156:157], v57 offset:0
    ds_read_b64_tr_b16 v[158:159], v57 offset:512
    v_mfma_f32_16x16x32_bf16 v[96:99], v[196:199], v[180:183], v[96:99]
    ds_read_b128 v[132:135], v52 offset:0
    ds_read_b64_tr_b16 v[160:161], v57 offset:8192
    v_mfma_f32_16x16x32_bf16 v[120:123], v[180:183], v[200:203], v[120:123]
    ds_read_b64_tr_b16 v[162:163], v57 offset:8704
    ds_read_b64_tr_b16 v[164:165], v57 offset:16384
    v_mfma_f32_16x16x32_bf16 v[76:79], v[192:195], v[184:187], v[76:79]
    ds_read_b64_tr_b16 v[166:167], v57 offset:16896
    ds_read_b128 v[136:139], v52 offset:2048
    v_mfma_f32_16x16x32_bf16 v[100:103], v[196:199], v[184:187], v[100:103]
    ds_read_b128 v[140:143], v52 offset:4096
    ds_read_b128 v[144:147], v52 offset:6144
    v_mfma_f32_16x16x32_bf16 v[124:127], v[184:187], v[200:203], v[124:127]
    ds_read_b128 v[148:151], v52 offset:8192
    ds_read_b128 v[152:155], v52 offset:10240
    v_mfma_f32_16x16x32_bf16 v[80:83], v[192:195], v[188:191], v[80:83]
    v_mfma_f32_16x16x32_bf16 v[104:107], v[196:199], v[188:191], v[104:107]
    v_mfma_f32_16x16x32_bf16 v[128:131], v[188:191], v[200:203], v[128:131]
    s_waitcnt lgkmcnt(9)
    v_mfma_f32_16x16x32_bf16 v[60:63], v[156:159], v[132:135], v[60:63]
    ds_read_b64_tr_b16 v[192:193], v57 offset:4096
    s_waitcnt lgkmcnt(8)
    v_mfma_f32_16x16x32_bf16 v[84:87], v[160:163], v[132:135], v[84:87]
    ds_read_b64_tr_b16 v[194:195], v57 offset:4608
    s_waitcnt lgkmcnt(7)
    v_mfma_f32_16x16x32_bf16 v[108:111], v[132:135], v[164:167], v[108:111]
    ds_read_b128 v[168:171], v53 offset:0
    s_waitcnt lgkmcnt(7)
    v_mfma_f32_16x16x32_bf16 v[64:67], v[156:159], v[136:139], v[64:67]
    ds_read_b64_tr_b16 v[196:197], v57 offset:12288
    v_mfma_f32_16x16x32_bf16 v[88:91], v[160:163], v[136:139], v[88:91]
    ds_read_b64_tr_b16 v[198:199], v57 offset:12800
    v_mfma_f32_16x16x32_bf16 v[112:115], v[136:139], v[164:167], v[112:115]
    s_waitcnt lgkmcnt(5)
    ds_read_b64_tr_b16 v[200:201], v57 offset:20480
    v_mfma_f32_16x16x32_bf16 v[68:71], v[156:159], v[140:143], v[68:71]
    ds_read_b64_tr_b16 v[202:203], v57 offset:20992
    v_mfma_f32_16x16x32_bf16 v[92:95], v[160:163], v[140:143], v[92:95]
    ds_read_b128 v[172:175], v53 offset:2048
    v_mfma_f32_16x16x32_bf16 v[116:119], v[140:143], v[164:167], v[116:119]
    ds_read_b128 v[176:179], v53 offset:4096
    v_mfma_f32_16x16x32_bf16 v[72:75], v[156:159], v[144:147], v[72:75]
    ds_read_b128 v[180:183], v53 offset:6144
    v_mfma_f32_16x16x32_bf16 v[96:99], v[160:163], v[144:147], v[96:99]
    ds_read_b128 v[184:187], v53 offset:8192
    v_mfma_f32_16x16x32_bf16 v[120:123], v[144:147], v[164:167], v[120:123]
    ds_read_b128 v[188:191], v53 offset:10240
    v_mfma_f32_16x16x32_bf16 v[76:79], v[156:159], v[148:151], v[76:79]
    v_mfma_f32_16x16x32_bf16 v[100:103], v[160:163], v[148:151], v[100:103]
    v_mfma_f32_16x16x32_bf16 v[124:127], v[148:151], v[164:167], v[124:127]
    v_mfma_f32_16x16x32_bf16 v[80:83], v[156:159], v[152:155], v[80:83]
    v_mfma_f32_16x16x32_bf16 v[104:107], v[160:163], v[152:155], v[104:107]
    v_mfma_f32_16x16x32_bf16 v[128:131], v[152:155], v[164:167], v[128:131]
    s_waitcnt lgkmcnt(0)
    v_mfma_f32_16x16x32_bf16 v[60:63], v[192:195], v[168:171], v[60:63]
    v_mfma_f32_16x16x32_bf16 v[84:87], v[196:199], v[168:171], v[84:87]
    v_mfma_f32_16x16x32_bf16 v[108:111], v[168:171], v[200:203], v[108:111]
    v_mfma_f32_16x16x32_bf16 v[64:67], v[192:195], v[172:175], v[64:67]
    v_mfma_f32_16x16x32_bf16 v[88:91], v[196:199], v[172:175], v[88:91]
    v_mfma_f32_16x16x32_bf16 v[112:115], v[172:175], v[200:203], v[112:115]
    v_mfma_f32_16x16x32_bf16 v[68:71], v[192:195], v[176:179], v[68:71]
    v_mfma_f32_16x16x32_bf16 v[92:95], v[196:199], v[176:179], v[92:95]
    v_mfma_f32_16x16x32_bf16 v[116:119], v[176:179], v[200:203], v[116:119]
    v_mfma_f32_16x16x32_bf16 v[72:75], v[192:195], v[180:183], v[72:75]
    s_barrier
    ds_read_b64_tr_b16 v[156:157], v56 offset:0
    ds_read_b64_tr_b16 v[158:159], v56 offset:512
    v_mfma_f32_16x16x32_bf16 v[96:99], v[196:199], v[180:183], v[96:99]
    ds_read_b128 v[132:135], v52 offset:36864
    ds_read_b64_tr_b16 v[160:161], v56 offset:8192
    v_mfma_f32_16x16x32_bf16 v[120:123], v[180:183], v[200:203], v[120:123]
    ds_read_b64_tr_b16 v[162:163], v56 offset:8704
    ds_read_b64_tr_b16 v[164:165], v56 offset:16384
    v_mfma_f32_16x16x32_bf16 v[76:79], v[192:195], v[184:187], v[76:79]
    ds_read_b64_tr_b16 v[166:167], v56 offset:16896
    ds_read_b128 v[136:139], v52 offset:38912
    v_mfma_f32_16x16x32_bf16 v[100:103], v[196:199], v[184:187], v[100:103]
    ds_read_b128 v[140:143], v52 offset:40960
    ds_read_b128 v[144:147], v52 offset:43008
    v_mfma_f32_16x16x32_bf16 v[124:127], v[184:187], v[200:203], v[124:127]
    ds_read_b128 v[148:151], v52 offset:45056
    ds_read_b128 v[152:155], v52 offset:47104
    v_mfma_f32_16x16x32_bf16 v[80:83], v[192:195], v[188:191], v[80:83]
    v_mfma_f32_16x16x32_bf16 v[104:107], v[196:199], v[188:191], v[104:107]
    v_mfma_f32_16x16x32_bf16 v[128:131], v[188:191], v[200:203], v[128:131]
    s_waitcnt lgkmcnt(9)
    v_mfma_f32_16x16x32_bf16 v[60:63], v[156:159], v[132:135], v[60:63]
    ds_read_b64_tr_b16 v[192:193], v56 offset:4096
    s_waitcnt lgkmcnt(8)
    v_mfma_f32_16x16x32_bf16 v[84:87], v[160:163], v[132:135], v[84:87]
    ds_read_b64_tr_b16 v[194:195], v56 offset:4608
    s_waitcnt lgkmcnt(7)
    v_mfma_f32_16x16x32_bf16 v[108:111], v[132:135], v[164:167], v[108:111]
    ds_read_b128 v[168:171], v53 offset:36864
    s_waitcnt lgkmcnt(7)
    v_mfma_f32_16x16x32_bf16 v[64:67], v[156:159], v[136:139], v[64:67]
    ds_read_b64_tr_b16 v[196:197], v56 offset:12288
    v_mfma_f32_16x16x32_bf16 v[88:91], v[160:163], v[136:139], v[88:91]
    ds_read_b64_tr_b16 v[198:199], v56 offset:12800
    v_mfma_f32_16x16x32_bf16 v[112:115], v[136:139], v[164:167], v[112:115]
    s_waitcnt lgkmcnt(5)
    ds_read_b64_tr_b16 v[200:201], v56 offset:20480
    v_mfma_f32_16x16x32_bf16 v[68:71], v[156:159], v[140:143], v[68:71]
    ds_read_b64_tr_b16 v[202:203], v56 offset:20992
    v_mfma_f32_16x16x32_bf16 v[92:95], v[160:163], v[140:143], v[92:95]
    ds_read_b128 v[172:175], v53 offset:38912
    v_mfma_f32_16x16x32_bf16 v[116:119], v[140:143], v[164:167], v[116:119]
    ds_read_b128 v[176:179], v53 offset:40960
    v_mfma_f32_16x16x32_bf16 v[72:75], v[156:159], v[144:147], v[72:75]
    ds_read_b128 v[180:183], v53 offset:43008
    v_mfma_f32_16x16x32_bf16 v[96:99], v[160:163], v[144:147], v[96:99]
    ds_read_b128 v[184:187], v53 offset:45056
    v_mfma_f32_16x16x32_bf16 v[120:123], v[144:147], v[164:167], v[120:123]
    ds_read_b128 v[188:191], v53 offset:47104
    v_mfma_f32_16x16x32_bf16 v[76:79], v[156:159], v[148:151], v[76:79]
    v_mfma_f32_16x16x32_bf16 v[100:103], v[160:163], v[148:151], v[100:103]
    v_mfma_f32_16x16x32_bf16 v[124:127], v[148:151], v[164:167], v[124:127]
    v_mfma_f32_16x16x32_bf16 v[80:83], v[156:159], v[152:155], v[80:83]
    v_mfma_f32_16x16x32_bf16 v[104:107], v[160:163], v[152:155], v[104:107]
    v_mfma_f32_16x16x32_bf16 v[128:131], v[152:155], v[164:167], v[128:131]
    s_waitcnt lgkmcnt(0)
    v_mfma_f32_16x16x32_bf16 v[60:63], v[192:195], v[168:171], v[60:63]
    v_mfma_f32_16x16x32_bf16 v[84:87], v[196:199], v[168:171], v[84:87]
    v_mfma_f32_16x16x32_bf16 v[108:111], v[168:171], v[200:203], v[108:111]
    v_mfma_f32_16x16x32_bf16 v[64:67], v[192:195], v[172:175], v[64:67]
    v_mfma_f32_16x16x32_bf16 v[88:91], v[196:199], v[172:175], v[88:91]
    v_mfma_f32_16x16x32_bf16 v[112:115], v[172:175], v[200:203], v[112:115]
    v_mfma_f32_16x16x32_bf16 v[68:71], v[192:195], v[176:179], v[68:71]
    v_mfma_f32_16x16x32_bf16 v[92:95], v[196:199], v[176:179], v[92:95]
    v_mfma_f32_16x16x32_bf16 v[116:119], v[176:179], v[200:203], v[116:119]
    v_mfma_f32_16x16x32_bf16 v[72:75], v[192:195], v[180:183], v[72:75]
    s_barrier
    ds_read_b64_tr_b16 v[156:157], v56 offset:36864
    ds_read_b64_tr_b16 v[158:159], v56 offset:37376
    v_mfma_f32_16x16x32_bf16 v[96:99], v[196:199], v[180:183], v[96:99]
    ds_read_b128 v[132:135], v54 offset:0
    ds_read_b64_tr_b16 v[160:161], v56 offset:45056
    v_mfma_f32_16x16x32_bf16 v[120:123], v[180:183], v[200:203], v[120:123]
    ds_read_b64_tr_b16 v[162:163], v56 offset:45568
    ds_read_b64_tr_b16 v[164:165], v56 offset:53248
    v_mfma_f32_16x16x32_bf16 v[76:79], v[192:195], v[184:187], v[76:79]
    ds_read_b64_tr_b16 v[166:167], v56 offset:53760
    ds_read_b128 v[136:139], v54 offset:2048
    v_mfma_f32_16x16x32_bf16 v[100:103], v[196:199], v[184:187], v[100:103]
    ds_read_b128 v[140:143], v54 offset:4096
    ds_read_b128 v[144:147], v54 offset:6144
    v_mfma_f32_16x16x32_bf16 v[124:127], v[184:187], v[200:203], v[124:127]
    ds_read_b128 v[148:151], v54 offset:8192
    ds_read_b128 v[152:155], v54 offset:10240
    v_mfma_f32_16x16x32_bf16 v[80:83], v[192:195], v[188:191], v[80:83]
    v_mfma_f32_16x16x32_bf16 v[104:107], v[196:199], v[188:191], v[104:107]
    v_mfma_f32_16x16x32_bf16 v[128:131], v[188:191], v[200:203], v[128:131]
    s_waitcnt lgkmcnt(9)
    v_mfma_f32_16x16x32_bf16 v[60:63], v[156:159], v[132:135], v[60:63]
    ds_read_b64_tr_b16 v[192:193], v56 offset:40960
    s_waitcnt lgkmcnt(8)
    v_mfma_f32_16x16x32_bf16 v[84:87], v[160:163], v[132:135], v[84:87]
    ds_read_b64_tr_b16 v[194:195], v56 offset:41472
    s_waitcnt lgkmcnt(7)
    v_mfma_f32_16x16x32_bf16 v[108:111], v[132:135], v[164:167], v[108:111]
    ds_read_b128 v[168:171], v55 offset:0
    s_waitcnt lgkmcnt(7)
    v_mfma_f32_16x16x32_bf16 v[64:67], v[156:159], v[136:139], v[64:67]
    ds_read_b64_tr_b16 v[196:197], v56 offset:49152
    v_mfma_f32_16x16x32_bf16 v[88:91], v[160:163], v[136:139], v[88:91]
    ds_read_b64_tr_b16 v[198:199], v56 offset:49664
    v_mfma_f32_16x16x32_bf16 v[112:115], v[136:139], v[164:167], v[112:115]
    s_waitcnt lgkmcnt(5)
    ds_read_b64_tr_b16 v[200:201], v56 offset:57344
    v_mfma_f32_16x16x32_bf16 v[68:71], v[156:159], v[140:143], v[68:71]
    ds_read_b64_tr_b16 v[202:203], v56 offset:57856
    v_mfma_f32_16x16x32_bf16 v[92:95], v[160:163], v[140:143], v[92:95]
    ds_read_b128 v[172:175], v55 offset:2048
    v_mfma_f32_16x16x32_bf16 v[116:119], v[140:143], v[164:167], v[116:119]
    ds_read_b128 v[176:179], v55 offset:4096
    v_mfma_f32_16x16x32_bf16 v[72:75], v[156:159], v[144:147], v[72:75]
    ds_read_b128 v[180:183], v55 offset:6144
    v_mfma_f32_16x16x32_bf16 v[96:99], v[160:163], v[144:147], v[96:99]
    ds_read_b128 v[184:187], v55 offset:8192
    v_mfma_f32_16x16x32_bf16 v[120:123], v[144:147], v[164:167], v[120:123]
    ds_read_b128 v[188:191], v55 offset:10240
    v_mfma_f32_16x16x32_bf16 v[76:79], v[156:159], v[148:151], v[76:79]
    v_mfma_f32_16x16x32_bf16 v[100:103], v[160:163], v[148:151], v[100:103]
    v_mfma_f32_16x16x32_bf16 v[124:127], v[148:151], v[164:167], v[124:127]
    v_mfma_f32_16x16x32_bf16 v[80:83], v[156:159], v[152:155], v[80:83]
    v_mfma_f32_16x16x32_bf16 v[104:107], v[160:163], v[152:155], v[104:107]
    v_mfma_f32_16x16x32_bf16 v[128:131], v[152:155], v[164:167], v[128:131]
    s_waitcnt lgkmcnt(0)
    v_mfma_f32_16x16x32_bf16 v[60:63], v[192:195], v[168:171], v[60:63]
    v_mfma_f32_16x16x32_bf16 v[84:87], v[196:199], v[168:171], v[84:87]
    v_mfma_f32_16x16x32_bf16 v[108:111], v[168:171], v[200:203], v[108:111]
    v_mfma_f32_16x16x32_bf16 v[64:67], v[192:195], v[172:175], v[64:67]
    v_mfma_f32_16x16x32_bf16 v[88:91], v[196:199], v[172:175], v[88:91]
    v_mfma_f32_16x16x32_bf16 v[112:115], v[172:175], v[200:203], v[112:115]
    v_mfma_f32_16x16x32_bf16 v[68:71], v[192:195], v[176:179], v[68:71]
    v_mfma_f32_16x16x32_bf16 v[92:95], v[196:199], v[176:179], v[92:95]
    v_mfma_f32_16x16x32_bf16 v[116:119], v[176:179], v[200:203], v[116:119]
    v_mfma_f32_16x16x32_bf16 v[72:75], v[192:195], v[180:183], v[72:75]
    s_barrier
    ds_read_b64_tr_b16 v[156:157], v57 offset:0
    ds_read_b64_tr_b16 v[158:159], v57 offset:512
    v_mfma_f32_16x16x32_bf16 v[96:99], v[196:199], v[180:183], v[96:99]
    ds_read_b128 v[132:135], v54 offset:39936
    ds_read_b64_tr_b16 v[160:161], v57 offset:8192
    v_mfma_f32_16x16x32_bf16 v[120:123], v[180:183], v[200:203], v[120:123]
    ds_read_b64_tr_b16 v[162:163], v57 offset:8704
    ds_read_b64_tr_b16 v[164:165], v57 offset:16384
    v_mfma_f32_16x16x32_bf16 v[76:79], v[192:195], v[184:187], v[76:79]
    ds_read_b64_tr_b16 v[166:167], v57 offset:16896
    ds_read_b128 v[136:139], v54 offset:41984
    v_mfma_f32_16x16x32_bf16 v[100:103], v[196:199], v[184:187], v[100:103]
    ds_read_b128 v[140:143], v54 offset:44032
    ds_read_b128 v[144:147], v54 offset:46080
    v_mfma_f32_16x16x32_bf16 v[124:127], v[184:187], v[200:203], v[124:127]
    ds_read_b128 v[148:151], v54 offset:48128
    ds_read_b128 v[152:155], v54 offset:50176
    v_mfma_f32_16x16x32_bf16 v[80:83], v[192:195], v[188:191], v[80:83]
    v_mfma_f32_16x16x32_bf16 v[104:107], v[196:199], v[188:191], v[104:107]
    v_mfma_f32_16x16x32_bf16 v[128:131], v[188:191], v[200:203], v[128:131]
    s_waitcnt lgkmcnt(9)
    v_mfma_f32_16x16x32_bf16 v[60:63], v[156:159], v[132:135], v[60:63]
    ds_read_b64_tr_b16 v[192:193], v57 offset:4096
    s_waitcnt lgkmcnt(8)
    v_mfma_f32_16x16x32_bf16 v[84:87], v[160:163], v[132:135], v[84:87]
    ds_read_b64_tr_b16 v[194:195], v57 offset:4608
    s_waitcnt lgkmcnt(7)
    v_mfma_f32_16x16x32_bf16 v[108:111], v[132:135], v[164:167], v[108:111]
    ds_read_b128 v[168:171], v55 offset:39936
    s_waitcnt lgkmcnt(7)
    v_mfma_f32_16x16x32_bf16 v[64:67], v[156:159], v[136:139], v[64:67]
    ds_read_b64_tr_b16 v[196:197], v57 offset:12288
    v_mfma_f32_16x16x32_bf16 v[88:91], v[160:163], v[136:139], v[88:91]
    ds_read_b64_tr_b16 v[198:199], v57 offset:12800
    v_mfma_f32_16x16x32_bf16 v[112:115], v[136:139], v[164:167], v[112:115]
    s_waitcnt lgkmcnt(5)
    ds_read_b64_tr_b16 v[200:201], v57 offset:20480
    v_mfma_f32_16x16x32_bf16 v[68:71], v[156:159], v[140:143], v[68:71]
    ds_read_b64_tr_b16 v[202:203], v57 offset:20992
    v_mfma_f32_16x16x32_bf16 v[92:95], v[160:163], v[140:143], v[92:95]
    ds_read_b128 v[172:175], v55 offset:41984
    v_mfma_f32_16x16x32_bf16 v[116:119], v[140:143], v[164:167], v[116:119]
    ds_read_b128 v[176:179], v55 offset:44032
    v_mfma_f32_16x16x32_bf16 v[72:75], v[156:159], v[144:147], v[72:75]
    ds_read_b128 v[180:183], v55 offset:46080
    v_mfma_f32_16x16x32_bf16 v[96:99], v[160:163], v[144:147], v[96:99]
    ds_read_b128 v[184:187], v55 offset:48128
    v_mfma_f32_16x16x32_bf16 v[120:123], v[144:147], v[164:167], v[120:123]
    ds_read_b128 v[188:191], v55 offset:50176
    v_mfma_f32_16x16x32_bf16 v[76:79], v[156:159], v[148:151], v[76:79]
    v_mfma_f32_16x16x32_bf16 v[100:103], v[160:163], v[148:151], v[100:103]
    v_mfma_f32_16x16x32_bf16 v[124:127], v[148:151], v[164:167], v[124:127]
    v_mfma_f32_16x16x32_bf16 v[80:83], v[156:159], v[152:155], v[80:83]
    v_mfma_f32_16x16x32_bf16 v[104:107], v[160:163], v[152:155], v[104:107]
    v_mfma_f32_16x16x32_bf16 v[128:131], v[152:155], v[164:167], v[128:131]
    s_waitcnt lgkmcnt(0)
    v_mfma_f32_16x16x32_bf16 v[60:63], v[192:195], v[168:171], v[60:63]
    v_mfma_f32_16x16x32_bf16 v[84:87], v[196:199], v[168:171], v[84:87]
    v_mfma_f32_16x16x32_bf16 v[108:111], v[168:171], v[200:203], v[108:111]
    v_mfma_f32_16x16x32_bf16 v[64:67], v[192:195], v[172:175], v[64:67]
    v_mfma_f32_16x16x32_bf16 v[88:91], v[196:199], v[172:175], v[88:91]
    v_mfma_f32_16x16x32_bf16 v[112:115], v[172:175], v[200:203], v[112:115]
    v_mfma_f32_16x16x32_bf16 v[68:71], v[192:195], v[176:179], v[68:71]
    v_mfma_f32_16x16x32_bf16 v[92:95], v[196:199], v[176:179], v[92:95]
    v_mfma_f32_16x16x32_bf16 v[116:119], v[176:179], v[200:203], v[116:119]
    v_mfma_f32_16x16x32_bf16 v[72:75], v[192:195], v[180:183], v[72:75]
    s_barrier
    ds_read_b64_tr_b16 v[156:157], v56 offset:0
    ds_read_b64_tr_b16 v[158:159], v56 offset:512
    v_mfma_f32_16x16x32_bf16 v[96:99], v[196:199], v[180:183], v[96:99]
    ds_read_b128 v[132:135], v52 offset:0
    ds_read_b64_tr_b16 v[160:161], v56 offset:8192
    v_mfma_f32_16x16x32_bf16 v[120:123], v[180:183], v[200:203], v[120:123]
    ds_read_b64_tr_b16 v[162:163], v56 offset:8704
    ds_read_b64_tr_b16 v[164:165], v56 offset:16384
    v_mfma_f32_16x16x32_bf16 v[76:79], v[192:195], v[184:187], v[76:79]
    ds_read_b64_tr_b16 v[166:167], v56 offset:16896
    ds_read_b128 v[136:139], v52 offset:2048
    v_mfma_f32_16x16x32_bf16 v[100:103], v[196:199], v[184:187], v[100:103]
    ds_read_b128 v[140:143], v52 offset:4096
    ds_read_b128 v[144:147], v52 offset:6144
    v_mfma_f32_16x16x32_bf16 v[124:127], v[184:187], v[200:203], v[124:127]
    ds_read_b128 v[148:151], v52 offset:8192
    ds_read_b128 v[152:155], v52 offset:10240
    v_mfma_f32_16x16x32_bf16 v[80:83], v[192:195], v[188:191], v[80:83]
    v_mfma_f32_16x16x32_bf16 v[104:107], v[196:199], v[188:191], v[104:107]
    v_mfma_f32_16x16x32_bf16 v[128:131], v[188:191], v[200:203], v[128:131]
    s_waitcnt lgkmcnt(9)
    v_mfma_f32_16x16x32_bf16 v[60:63], v[156:159], v[132:135], v[60:63]
    ds_read_b64_tr_b16 v[192:193], v56 offset:4096
    s_waitcnt lgkmcnt(8)
    v_mfma_f32_16x16x32_bf16 v[84:87], v[160:163], v[132:135], v[84:87]
    ds_read_b64_tr_b16 v[194:195], v56 offset:4608
    s_waitcnt lgkmcnt(7)
    v_mfma_f32_16x16x32_bf16 v[108:111], v[132:135], v[164:167], v[108:111]
    ds_read_b128 v[168:171], v53 offset:0
    s_waitcnt lgkmcnt(7)
    v_mfma_f32_16x16x32_bf16 v[64:67], v[156:159], v[136:139], v[64:67]
    ds_read_b64_tr_b16 v[196:197], v56 offset:12288
    v_mfma_f32_16x16x32_bf16 v[88:91], v[160:163], v[136:139], v[88:91]
    ds_read_b64_tr_b16 v[198:199], v56 offset:12800
    v_mfma_f32_16x16x32_bf16 v[112:115], v[136:139], v[164:167], v[112:115]
    s_waitcnt lgkmcnt(5)
    ds_read_b64_tr_b16 v[200:201], v56 offset:20480
    v_mfma_f32_16x16x32_bf16 v[68:71], v[156:159], v[140:143], v[68:71]
    ds_read_b64_tr_b16 v[202:203], v56 offset:20992
    v_mfma_f32_16x16x32_bf16 v[92:95], v[160:163], v[140:143], v[92:95]
    ds_read_b128 v[172:175], v53 offset:2048
    v_mfma_f32_16x16x32_bf16 v[116:119], v[140:143], v[164:167], v[116:119]
    ds_read_b128 v[176:179], v53 offset:4096
    v_mfma_f32_16x16x32_bf16 v[72:75], v[156:159], v[144:147], v[72:75]
    ds_read_b128 v[180:183], v53 offset:6144
    v_mfma_f32_16x16x32_bf16 v[96:99], v[160:163], v[144:147], v[96:99]
    ds_read_b128 v[184:187], v53 offset:8192
    v_mfma_f32_16x16x32_bf16 v[120:123], v[144:147], v[164:167], v[120:123]
    ds_read_b128 v[188:191], v53 offset:10240
    v_mfma_f32_16x16x32_bf16 v[76:79], v[156:159], v[148:151], v[76:79]
    v_mfma_f32_16x16x32_bf16 v[100:103], v[160:163], v[148:151], v[100:103]
    v_mfma_f32_16x16x32_bf16 v[124:127], v[148:151], v[164:167], v[124:127]
    v_mfma_f32_16x16x32_bf16 v[80:83], v[156:159], v[152:155], v[80:83]
    v_mfma_f32_16x16x32_bf16 v[104:107], v[160:163], v[152:155], v[104:107]
    v_mfma_f32_16x16x32_bf16 v[128:131], v[152:155], v[164:167], v[128:131]
    s_waitcnt lgkmcnt(0)
    v_mfma_f32_16x16x32_bf16 v[60:63], v[192:195], v[168:171], v[60:63]
    v_mfma_f32_16x16x32_bf16 v[84:87], v[196:199], v[168:171], v[84:87]
    v_mfma_f32_16x16x32_bf16 v[108:111], v[168:171], v[200:203], v[108:111]
    v_mfma_f32_16x16x32_bf16 v[64:67], v[192:195], v[172:175], v[64:67]
    v_mfma_f32_16x16x32_bf16 v[88:91], v[196:199], v[172:175], v[88:91]
    v_mfma_f32_16x16x32_bf16 v[112:115], v[172:175], v[200:203], v[112:115]
    v_mfma_f32_16x16x32_bf16 v[68:71], v[192:195], v[176:179], v[68:71]
    v_mfma_f32_16x16x32_bf16 v[92:95], v[196:199], v[176:179], v[92:95]
    v_mfma_f32_16x16x32_bf16 v[116:119], v[176:179], v[200:203], v[116:119]
    v_mfma_f32_16x16x32_bf16 v[72:75], v[192:195], v[180:183], v[72:75]
    s_barrier
    ds_read_b64_tr_b16 v[156:157], v56 offset:36864
    ds_read_b64_tr_b16 v[158:159], v56 offset:37376
    v_mfma_f32_16x16x32_bf16 v[96:99], v[196:199], v[180:183], v[96:99]
    ds_read_b128 v[132:135], v52 offset:36864
    ds_read_b64_tr_b16 v[160:161], v56 offset:45056
    v_mfma_f32_16x16x32_bf16 v[120:123], v[180:183], v[200:203], v[120:123]
    ds_read_b64_tr_b16 v[162:163], v56 offset:45568
    ds_read_b64_tr_b16 v[164:165], v56 offset:53248
    v_mfma_f32_16x16x32_bf16 v[76:79], v[192:195], v[184:187], v[76:79]
    ds_read_b64_tr_b16 v[166:167], v56 offset:53760
    ds_read_b64_tr_b16 v[236:237], v56 offset:40960
    v_mfma_f32_16x16x32_bf16 v[100:103], v[196:199], v[184:187], v[100:103]
    ds_read_b64_tr_b16 v[238:239], v56 offset:41472
    ds_read_b128 v[212:215], v53 offset:36864
    v_mfma_f32_16x16x32_bf16 v[124:127], v[184:187], v[200:203], v[124:127]
    ds_read_b64_tr_b16 v[240:241], v56 offset:49152
    ds_read_b64_tr_b16 v[242:243], v56 offset:49664
    v_mfma_f32_16x16x32_bf16 v[80:83], v[192:195], v[188:191], v[80:83]
    ds_read_b64_tr_b16 v[244:245], v56 offset:57344
    ds_read_b64_tr_b16 v[246:247], v56 offset:57856
    v_mfma_f32_16x16x32_bf16 v[104:107], v[196:199], v[188:191], v[104:107]
    ds_read_b128 v[136:139], v52 offset:38912
    ds_read_b128 v[140:143], v52 offset:40960
    v_mfma_f32_16x16x32_bf16 v[128:131], v[188:191], v[200:203], v[128:131]
    s_waitcnt lgkmcnt(13)
    v_mfma_f32_16x16x32_bf16 v[60:63], v[156:159], v[132:135], v[60:63]
    ds_read_b128 v[216:219], v53 offset:38912
    ds_read_b128 v[144:147], v52 offset:43008
    s_waitcnt lgkmcnt(8)
    v_mfma_f32_16x16x32_bf16 v[60:63], v[236:239], v[212:215], v[60:63]
    ds_read_b128 v[220:223], v53 offset:40960
    ds_read_b128 v[148:151], v52 offset:45056
    v_mfma_f32_16x16x32_bf16 v[84:87], v[160:163], v[132:135], v[84:87]
    s_waitcnt lgkmcnt(8)
    v_mfma_f32_16x16x32_bf16 v[84:87], v[240:243], v[212:215], v[84:87]
    ds_read_b128 v[224:227], v53 offset:43008
    ds_read_b128 v[152:155], v52 offset:47104
    v_mfma_f32_16x16x32_bf16 v[108:111], v[132:135], v[164:167], v[108:111]
    s_waitcnt lgkmcnt(8)
    v_mfma_f32_16x16x32_bf16 v[108:111], v[212:215], v[244:247], v[108:111]
    ds_read_b128 v[228:231], v53 offset:45056
    ds_read_b128 v[232:235], v53 offset:47104
    s_waitcnt lgkmcnt(9)
    v_mfma_f32_16x16x32_bf16 v[64:67], v[156:159], v[136:139], v[64:67]
    s_waitcnt lgkmcnt(7)
    v_mfma_f32_16x16x32_bf16 v[64:67], v[236:239], v[216:219], v[64:67]
    ds_read_b32 v46, v45
    v_mfma_f32_16x16x32_bf16 v[88:91], v[160:163], v[136:139], v[88:91]
    v_cvt_pk_bf16_f32 v60, v60, v61
    v_cvt_pk_bf16_f32 v61, v62, v63
    v_mfma_f32_16x16x32_bf16 v[88:91], v[240:243], v[216:219], v[88:91]
    ds_write_b64 v59, v[60:61] offset:0
    v_mfma_f32_16x16x32_bf16 v[112:115], v[136:139], v[164:167], v[112:115]
    v_cvt_pk_bf16_f32 v84, v84, v85
    v_cvt_pk_bf16_f32 v85, v86, v87
    v_mfma_f32_16x16x32_bf16 v[112:115], v[216:219], v[244:247], v[112:115]
    ds_write_b64 v59, v[84:85] offset:2048
    v_mfma_f32_16x16x32_bf16 v[68:71], v[156:159], v[140:143], v[68:71]
    v_cvt_pk_bf16_f32 v108, v108, v110
    v_cvt_pk_bf16_f32 v109, v109, v111
    s_waitcnt lgkmcnt(8)
    v_mfma_f32_16x16x32_bf16 v[68:71], v[236:239], v[220:223], v[68:71]
    ds_write_b64 v58, v[108:109] offset:4096
    v_mfma_f32_16x16x32_bf16 v[92:95], v[160:163], v[140:143], v[92:95]
    v_cvt_pk_bf16_f32 v64, v64, v65
    v_cvt_pk_bf16_f32 v65, v66, v67
    v_mfma_f32_16x16x32_bf16 v[92:95], v[240:243], v[220:223], v[92:95]
    ds_write_b64 v59, v[64:65] offset:6144
    v_mfma_f32_16x16x32_bf16 v[116:119], v[140:143], v[164:167], v[116:119]
    v_cvt_pk_bf16_f32 v88, v88, v89
    v_cvt_pk_bf16_f32 v89, v90, v91
    v_mfma_f32_16x16x32_bf16 v[116:119], v[220:223], v[244:247], v[116:119]
    ds_write_b64 v59, v[88:89] offset:8192
    v_mfma_f32_16x16x32_bf16 v[72:75], v[156:159], v[144:147], v[72:75]
    v_cvt_pk_bf16_f32 v112, v112, v114
    v_cvt_pk_bf16_f32 v113, v113, v115
    s_waitcnt lgkmcnt(5)
    v_readfirstlane_b32 s39, v46
    s_waitcnt vmcnt(0)
    v_mfma_f32_16x16x32_bf16 v[72:75], v[236:239], v[224:227], v[72:75]
    ds_write_b64 v58, v[112:113] offset:10240
    v_mfma_f32_16x16x32_bf16 v[96:99], v[160:163], v[144:147], v[96:99]
    v_cvt_pk_bf16_f32 v68, v68, v69
    v_cvt_pk_bf16_f32 v69, v70, v71
    v_mfma_f32_16x16x32_bf16 v[96:99], v[240:243], v[224:227], v[96:99]
    ds_write_b64 v59, v[68:69] offset:12288
    v_mfma_f32_16x16x32_bf16 v[120:123], v[144:147], v[164:167], v[120:123]
    v_cvt_pk_bf16_f32 v92, v92, v93
    v_cvt_pk_bf16_f32 v93, v94, v95
    v_mfma_f32_16x16x32_bf16 v[120:123], v[224:227], v[244:247], v[120:123]
    ds_write_b64 v59, v[92:93] offset:14336
    v_mfma_f32_16x16x32_bf16 v[76:79], v[156:159], v[148:151], v[76:79]
    v_cvt_pk_bf16_f32 v116, v116, v118
    v_cvt_pk_bf16_f32 v117, v117, v119
    v_mfma_f32_16x16x32_bf16 v[76:79], v[236:239], v[228:231], v[76:79]
    ds_write_b64 v58, v[116:117] offset:16384
    v_mfma_f32_16x16x32_bf16 v[100:103], v[160:163], v[148:151], v[100:103]
    v_cvt_pk_bf16_f32 v72, v72, v73
    v_cvt_pk_bf16_f32 v73, v74, v75
    v_mfma_f32_16x16x32_bf16 v[100:103], v[240:243], v[228:231], v[100:103]
    ds_write_b64 v59, v[72:73] offset:18432
    v_mfma_f32_16x16x32_bf16 v[124:127], v[148:151], v[164:167], v[124:127]
    v_cvt_pk_bf16_f32 v96, v96, v97
    v_cvt_pk_bf16_f32 v97, v98, v99
    v_mfma_f32_16x16x32_bf16 v[124:127], v[228:231], v[244:247], v[124:127]
    ds_write_b64 v59, v[96:97] offset:20480
    v_mfma_f32_16x16x32_bf16 v[80:83], v[156:159], v[152:155], v[80:83]
    v_cvt_pk_bf16_f32 v120, v120, v122
    v_cvt_pk_bf16_f32 v121, v121, v123
    v_mfma_f32_16x16x32_bf16 v[80:83], v[236:239], v[232:235], v[80:83]
    ds_write_b64 v58, v[120:121] offset:22528
    v_mfma_f32_16x16x32_bf16 v[104:107], v[160:163], v[152:155], v[104:107]
    v_cvt_pk_bf16_f32 v76, v76, v77
    v_cvt_pk_bf16_f32 v77, v78, v79
    v_mfma_f32_16x16x32_bf16 v[104:107], v[240:243], v[232:235], v[104:107]
    ds_write_b64 v59, v[76:77] offset:24576
    v_mfma_f32_16x16x32_bf16 v[128:131], v[152:155], v[164:167], v[128:131]
    v_cvt_pk_bf16_f32 v100, v100, v101
    v_cvt_pk_bf16_f32 v101, v102, v103
    v_mfma_f32_16x16x32_bf16 v[128:131], v[232:235], v[244:247], v[128:131]
    ds_write_b64 v59, v[100:101] offset:26624
    v_cvt_pk_bf16_f32 v124, v124, v126
    v_cvt_pk_bf16_f32 v125, v125, v127
    v_cvt_pk_bf16_f32 v80, v80, v81
    v_cvt_pk_bf16_f32 v81, v82, v83
    v_cvt_pk_bf16_f32 v104, v104, v105
    v_cvt_pk_bf16_f32 v105, v106, v107
    s_nop 0
    v_cvt_pk_bf16_f32 v128, v128, v130
    v_cvt_pk_bf16_f32 v129, v129, v131
    ds_write_b64 v58, v[124:125] offset:28672
    ds_write_b64 v59, v[80:81] offset:30720
    ds_write_b64 v59, v[104:105] offset:32768
    ds_write_b64 v58, v[128:129] offset:34816
L_postC:
    s_waitcnt lgkmcnt(0)
    s_cmp_lg_u32 s39, s3
    s_cbranch_scc1 L_attnCq
L_attnCf:
    s_barrier
    ds_read_b128 v[112:115], v49 offset:0
    ds_read_b128 v[116:119], v49 offset:1024
    ds_read_b128 v[120:123], v49 offset:2048
    ds_read_b128 v[128:131], v50 offset:2048
    ds_read_b128 v[124:127], v49 offset:3072
    ds_read_b128 v[132:135], v50 offset:3072
    ds_read_b128 v[196:199], v49 offset:4096
    ds_read_b128 v[200:203], v50 offset:4096
    v_mov_b32 v210, 0
    v_mov_b32 v206, 0
    v_mov_b32 v218, 0
    v_mov_b32 v222, 0
    v_mov_b32 v225, 0
    ds_read_b128 v[192:195], v49 offset:5120
    ds_read_b128 v[52:55], v50 offset:5120
    v_mov_b32 v213, 0
    v_mov_b32 v58, 0
    s_waitcnt lgkmcnt(9)
    v_and_b32 v136, v13, v112
    v_and_b32 v137, v14, v113
    s_waitcnt lgkmcnt(8)
    v_and_b32 v148, v19, v118
    v_and_b32 v149, v20, v119
    v_xor_b32 v150, v148, v118
    v_xor_b32 v151, v149, v119
    s_waitcnt lgkmcnt(6)
    v_mfma_f32_16x16x16_bf16 v[152:155], v[128:129], v[136:137], v[6:9]
    v_and_b32 v140, v15, v114
    v_and_b32 v141, v16, v115
    v_mfma_f32_16x16x16_bf16 v[156:159], v[120:121], v[136:137], v[2:5]
    v_and_b32 v144, v17, v116
    v_and_b32 v145, v18, v117
    s_waitcnt lgkmcnt(4)
    v_mfma_f32_16x16x16_bf16 v[184:187], v[134:135], v[150:151], v[6:9]
    v_xor_b32 v138, v136, v112
    v_xor_b32 v139, v137, v113
    v_mfma_f32_16x16x16_bf16 v[188:191], v[126:127], v[150:151], v[2:5]
    v_xor_b32 v142, v140, v114
    v_xor_b32 v143, v141, v115
    v_max3_f32 v76, v153, v156, v157
    v_max3_f32 v77, v155, v158, v159
    buffer_store_dwordx2 v[76:77], v27, s[4:7], 0 offen
    v_xor_b32 v146, v144, v116
    v_xor_b32 v147, v145, v117
    v_mfma_f32_16x16x32_bf16 v[160:163], v[128:131], v[138:141], v[6:9]
    v_max3_f32 v84, v185, v188, v189
    v_max3_f32 v85, v187, v190, v191
    buffer_store_dwordx2 v[84:85], v28, s[4:7], 0 offen
    v_mfma_f32_16x16x32_bf16 v[164:167], v[120:123], v[138:141], v[2:5]
    s_waitcnt lgkmcnt(0)
    v_and_b32 v208, v23, v198
    v_and_b32 v209, v23, v199
    v_mfma_f32_16x16x32_bf16 v[168:171], v[130:133], v[142:145], v[6:9]
    v_and_b32 v211, v23, v203
    v_and_b32 v204, v22, v196
    v_mfma_f32_16x16x32_bf16 v[172:175], v[122:125], v[142:145], v[2:5]
    v_and_b32 v205, v22, v197
    v_and_b32 v207, v22, v201
    v_mfma_f32_16x16x32_bf16 v[176:179], v[132:135], v[146:149], v[6:9]
    v_max3_f32 v78, v161, v164, v165
    v_max3_f32 v79, v163, v166, v167
    v_mfma_f32_16x16x32_bf16 v[180:183], v[124:127], v[146:149], v[2:5]
    v_max_f32 v104, v78, v79
    v_xor_b32 v202, v209, v199
    v_max3_f32 v80, v169, v172, v173
    v_max3_f32 v81, v171, v174, v175
    v_max_f32 v106, v80, v81
    v_xor_b32 v200, v208, v198
    v_xor_b32 v203, v211, v203
    v_permlane16_swap_b32 v104, v106
    v_max3_f32 v82, v177, v180, v181
    v_max3_f32 v83, v179, v182, v183
    v_max_f32 v108, v82, v83
    v_max_f32 v110, v82, v83
    v_max_f32 v104, v104, v106
    v_xor_b32 v196, v204, v196
    v_permlane16_swap_b32 v108, v110
    v_max_f32 v108, v108, v110
    v_xor_b32 v197, v205, v197
    v_xor_b32 v199, v207, v201
    v_permlane32_swap_b32 v104, v108
    v_max_f32 v104, v104, v108
    v_mul_f32 v108, s46, v104
    v_mul_f32 v104, s46, v104
    v_and_b32 v214, v24, v195
    v_xor_b32 v54, v214, v195
    v_permlane32_swap_b32 v104, v108
    v_mov_b32 v106, v104
    v_pk_fma_f32 v[82:83], v[82:83], s[46:47], v[108:109] op_sel:[0,0,0] op_sel_hi:[1,1,0] neg_lo:[0,0,1] neg_hi:[0,0,1]
    v_exp_f32 v82, v82
    v_permlane16_swap_b32 v104, v106
    v_pk_fma_f32 v[78:79], v[78:79], s[46:47], v[104:105] op_sel:[0,0,0] op_sel_hi:[1,1,0] neg_lo:[0,0,1] neg_hi:[0,0,1]
    v_pk_fma_f32 v[80:81], v[80:81], s[46:47], v[106:107] op_sel:[0,0,0] op_sel_hi:[1,1,0] neg_lo:[0,0,1] neg_hi:[0,0,1]
    v_exp_f32 v78, v78
    v_exp_f32 v79, v79
    v_exp_f32 v80, v80
    v_exp_f32 v81, v81
    v_exp_f32 v83, v83
    v_add_f32 v104, v78, v79
    v_add_f32 v106, v80, v81
    v_add_f32 v108, v82, v83
    v_add_f32 v110, v82, v83
    v_permlane16_swap_b32 v104, v106
    v_add_f32 v104, v104, v106
    v_permlane16_swap_b32 v108, v110
    v_add_f32 v108, v108, v110
    v_and_b32 v56, v21, v192
    v_and_b32 v57, v21, v193
    v_permlane32_swap_b32 v104, v108
    v_add_f32 v104, v104, v108
    v_rcp_f32 v108, v104
    v_rcp_f32 v104, v104
    v_and_b32 v59, v21, v53
    v_and_b32 v212, v24, v194
    v_permlane32_swap_b32 v104, v108
    v_mov_b32 v106, v104
    v_pk_mul_f32 v[82:83], v[82:83], v[108:109] op_sel:[0,0] op_sel_hi:[1,0]
    v_cvt_pk_bf16_f32 v82, v82, v83
    v_permlane16_swap_b32 v104, v106
    v_pk_mul_f32 v[78:79], v[78:79], v[104:105] op_sel:[0,0] op_sel_hi:[1,0]
    v_pk_mul_f32 v[80:81], v[80:81], v[106:107] op_sel:[0,0] op_sel_hi:[1,0]
    v_cvt_pk_bf16_f32 v78, v78, v79
    v_cvt_pk_bf16_f32 v80, v80, v81
    v_and_b32 v216, v10, v78
    v_and_b32 v217, v11, v78
    v_and_b32 v219, v12, v78
    v_and_b32 v220, v10, v80
    v_and_b32 v221, v11, v80
    v_and_b32 v223, v12, v80
    v_mfma_f32_16x16x32_bf16 v[228:231], v[204:207], v[216:219], 0
    v_and_b32 v224, v10, v82
    v_and_b32 v226, v11, v82
    v_mfma_f32_16x16x32_bf16 v[232:235], v[208:211], v[220:223], 0
    v_and_b32 v227, v12, v82
    v_and_b32 v215, v24, v55
    v_mfma_f32_16x16x32_bf16 v[228:231], v[196:199], v[220:223], v[228:231]
    v_xor_b32 v192, v56, v192
    v_xor_b32 v193, v57, v193
    v_mfma_f32_16x16x32_bf16 v[232:235], v[200:203], v[224:227], v[232:235]
    v_xor_b32 v195, v59, v53
    v_xor_b32 v52, v212, v194
    v_mfma_f32_16x16x32_bf16 v[72:75], v[212:215], v[224:227], 0
    v_xor_b32 v55, v215, v55
    s_nop 0
    v_cvt_pk_bf16_f32 v96, v228, v229
    v_cvt_pk_bf16_f32 v97, v230, v231
    v_mfma_f32_16x16x32_bf16 v[68:71], v[192:195], v[216:219], 0
    v_cvt_pk_bf16_f32 v98, v232, v233
    v_cvt_pk_bf16_f32 v99, v234, v235
    buffer_store_dwordx4 v[96:99], v25, s[4:7], 0 offen
    buffer_load_dwordx2 v[86:87], v29, s[4:7], 0 offen sc1
    buffer_load_dwordx2 v[88:89], v30, s[4:7], 0 offen sc1
    s_waitcnt vmcnt(2)
    buffer_store_dword v1, v32, s[20:23], 0 offen offset:36
    s_waitcnt vmcnt(1)
    v_max3_u32 v94, v86, v87, v88
    v_max_u32 v94, v94, v89
    v_cmp_eq_u32 vcc, -1, v94
    s_cbranch_vccnz L_c1rCf
L_c1dCf:
    v_pk_add_f32 v[76:77], v[76:77], v[86:87]
    v_pk_add_f32 v[84:85], v[84:85], v[88:89]
    v_max_f32 v104, v76, v77
    v_max_f32 v106, v84, v85
    v_mov_b32 v62, 0
    v_mov_b32 v65, 0
    v_permlane16_swap_b32 v104, v106
    v_max_f32 v104, v104, v106
    v_mov_b32 v106, v104
    ds_read_b32 v95, v45 offset:4
    s_nop 0
    v_permlane32_swap_b32 v104, v106
    v_max_f32 v104, v104, v106
    v_mul_f32 v106, s46, v104
    v_mul_f32 v104, s46, v104
    s_nop 1
    v_permlane16_swap_b32 v104, v106
    v_pk_fma_f32 v[76:77], v[76:77], s[46:47], v[104:105] op_sel:[0,0,0] op_sel_hi:[1,1,0] neg_lo:[0,0,1] neg_hi:[0,0,1]
    v_pk_fma_f32 v[84:85], v[84:85], s[46:47], v[106:107] op_sel:[0,0,0] op_sel_hi:[1,1,0] neg_lo:[0,0,1] neg_hi:[0,0,1]
    v_exp_f32 v76, v76
    v_exp_f32 v77, v77
    v_exp_f32 v84, v84
    v_exp_f32 v85, v85
    v_add_f32 v104, v76, v77
    v_add_f32 v106, v84, v85
    s_nop 1
    v_permlane16_swap_b32 v104, v106
    v_add_f32 v104, v104, v106
    v_mov_b32 v106, v104
    s_nop 1
    v_permlane32_swap_b32 v104, v106
    v_add_f32 v104, v104, v106
    v_rcp_f32 v106, v104
    v_rcp_f32 v104, v104
    s_nop 1
    v_permlane16_swap_b32 v104, v106
    v_pk_mul_f32 v[76:77], v[76:77], v[104:105] op_sel:[0,0] op_sel_hi:[1,0]
    v_pk_mul_f32 v[84:85], v[84:85], v[106:107] op_sel:[0,0] op_sel_hi:[1,0]
    v_cvt_pk_bf16_f32 v76, v76, v77
    v_cvt_pk_bf16_f32 v84, v84, v85
    v_and_b32 v60, v10, v76
    v_and_b32 v61, v11, v76
    v_and_b32 v63, v12, v76
    v_and_b32 v64, v10, v84
    v_and_b32 v66, v11, v84
    v_and_b32 v67, v12, v84
    v_mfma_f32_16x16x32_bf16 v[68:71], v[56:59], v[60:63], v[68:71]
    s_nop 0
    v_mfma_f32_16x16x32_bf16 v[72:75], v[52:55], v[64:67], v[72:75]
    s_nop 5
    v_cvt_pk_bf16_f32 v100, v68, v69
    v_cvt_pk_bf16_f32 v101, v70, v71
    v_cvt_pk_bf16_f32 v102, v72, v73
    v_cvt_pk_bf16_f32 v103, v74, v75
    buffer_store_dwordx4 v[100:103], v26, s[4:7], 0 offen
    s_waitcnt lgkmcnt(0)
    v_cmp_gt_u32 vcc, 2, v95
    s_cbranch_vccnz L_worCf
L_wodCf:
    ds_write_b128 v51, v[96:99]
    ds_write_b128 v51, v[100:103] offset:3072
    ds_read_b64_tr_b16 v[112:113], v34 offset:2048
    ds_read_b64_tr_b16 v[114:115], v34 offset:4096
    ds_read_b64_tr_b16 v[116:117], v35 offset:2048
    ds_read_b64_tr_b16 v[118:119], v35 offset:4096
    ds_read_b64_tr_b16 v[184:185], v34 offset:0
    ds_read_b64_tr_b16 v[186:187], v34 offset:6144
    ds_read_b64_tr_b16 v[188:189], v35 offset:0
    ds_read_b64_tr_b16 v[190:191], v35 offset:6144
    ds_read_b64_tr_b16 v[120:121], v34 offset:10240
    ds_read_b64_tr_b16 v[122:123], v34 offset:12288
    ds_read_b64_tr_b16 v[124:125], v35 offset:10240
    ds_read_b64_tr_b16 v[126:127], v35 offset:12288
    ds_read_b64_tr_b16 v[128:129], v34 offset:18432
    ds_read_b64_tr_b16 v[130:131], v34 offset:20480
    ds_read_b64_tr_b16 v[132:133], v35 offset:18432
    ds_read_b64_tr_b16 v[134:135], v35 offset:20480
    ds_read_b64_tr_b16 v[136:137], v34 offset:26624
    ds_read_b64_tr_b16 v[138:139], v34 offset:28672
    ds_read_b64_tr_b16 v[140:141], v35 offset:26624
    ds_read_b64_tr_b16 v[142:143], v35 offset:28672
    ds_read_b64_tr_b16 v[144:145], v36 offset:2048
    ds_read_b64_tr_b16 v[146:147], v36 offset:4096
    ds_read_b64_tr_b16 v[148:149], v37 offset:2048
    ds_read_b64_tr_b16 v[150:151], v37 offset:4096
    s_waitcnt vmcnt(0)
    buffer_store_dword v1, v32, s[20:23], 0 offen offset:72
    ds_read_b64_tr_b16 v[152:153], v36 offset:10240
    ds_read_b64_tr_b16 v[154:155], v36 offset:12288
    ds_read_b64_tr_b16 v[156:157], v37 offset:10240
    ds_read_b64_tr_b16 v[158:159], v37 offset:12288
    ds_read_b64_tr_b16 v[160:161], v36 offset:18432
    ds_read_b64_tr_b16 v[162:163], v36 offset:20480
    ds_read_b64_tr_b16 v[164:165], v37 offset:18432
    ds_read_b64_tr_b16 v[166:167], v37 offset:20480
    ds_read_b64_tr_b16 v[168:169], v36 offset:26624
    ds_read_b64_tr_b16 v[170:171], v36 offset:28672
    ds_read_b64_tr_b16 v[172:173], v37 offset:26624
    ds_read_b64_tr_b16 v[174:175], v37 offset:28672
    ds_read_b64_tr_b16 v[176:177], v36 offset:34816
    ds_read_b64_tr_b16 v[178:179], v36 offset:36864
    ds_read_b64_tr_b16 v[180:181], v37 offset:34816
    ds_read_b64_tr_b16 v[182:183], v37 offset:36864
    v_mov_b32 v45, s41
    s_waitcnt lgkmcnt(0)
    s_barrier
    ds_read_b128 v[76:79], v43 offset:0
    ds_read_b128 v[80:83], v43 offset:1024
    ds_read_b128 v[84:87], v43 offset:2048
    ds_read_b128 v[88:91], v43 offset:3072
    ds_read_b128 v[92:95], v43 offset:4096
    ds_read_b128 v[96:99], v43 offset:5120
    s_waitcnt lgkmcnt(5)
    v_mfma_f32_16x16x32_bf16 v[52:55], v[112:115], v[76:79], 0
    ds_read_b32 v108, v45 offset:68
    ds_read_b64_tr_b16 v[192:193], v34 offset:8192
    v_mfma_f32_16x16x32_bf16 v[56:59], v[116:119], v[76:79], 0
    ds_read_b64_tr_b16 v[194:195], v34 offset:14336
    s_waitcnt lgkmcnt(7)
    v_mfma_f32_16x16x32_bf16 v[60:63], v[112:115], v[80:83], 0
    ds_read_b64_tr_b16 v[196:197], v35 offset:8192
    ds_read_b64_tr_b16 v[198:199], v35 offset:14336
    v_mfma_f32_16x16x32_bf16 v[64:67], v[116:119], v[80:83], 0
    ds_read_b64_tr_b16 v[200:201], v34 offset:16384
    s_waitcnt lgkmcnt(9)
    v_mfma_f32_16x16x32_bf16 v[68:71], v[112:115], v[84:87], 0
    s_waitcnt lgkmcnt(5)
    v_cmp_eq_u32 vcc, 0, v108
    ds_read_b64_tr_b16 v[202:203], v34 offset:22528
    v_mfma_f32_16x16x32_bf16 v[72:75], v[116:119], v[84:87], 0
    ds_read_b64_tr_b16 v[204:205], v35 offset:16384
    v_mfma_f32_16x16x32_bf16 v[52:55], v[184:187], v[88:91], v[52:55]
    s_cbranch_vccnz L_m1rCf
L_m1dCf:
    ds_read_b128 v[100:103], v43 offset:6144
    v_mfma_f32_16x16x32_bf16 v[56:59], v[188:191], v[88:91], v[56:59]
    ds_read_b128 v[104:107], v43 offset:7168
    v_mfma_f32_16x16x32_bf16 v[60:63], v[184:187], v[92:95], v[60:63]
    ds_read_b32 v108, v45 offset:72
    ds_read_b128 v[76:79], v43 offset:8192
    v_mfma_f32_16x16x32_bf16 v[64:67], v[188:191], v[92:95], v[64:67]
    ds_read_b128 v[80:83], v43 offset:9216
    v_mfma_f32_16x16x32_bf16 v[68:71], v[184:187], v[96:99], v[68:71]
    ds_read_b64_tr_b16 v[206:207], v35 offset:22528
    ds_read_b64_tr_b16 v[208:209], v34 offset:24576
    v_mfma_f32_16x16x32_bf16 v[72:75], v[188:191], v[96:99], v[72:75]
    ds_read_b64_tr_b16 v[210:211], v34 offset:30720
    s_waitcnt lgkmcnt(7)
    v_mfma_f32_16x16x32_bf16 v[52:55], v[120:123], v[100:103], v[52:55]
    s_waitcnt lgkmcnt(5)
    v_cmp_eq_u32 vcc, 0, v108
    ds_read_b64_tr_b16 v[212:213], v35 offset:24576
    v_mfma_f32_16x16x32_bf16 v[56:59], v[124:127], v[100:103], v[56:59]
    ds_read_b64_tr_b16 v[214:215], v35 offset:30720
    v_mfma_f32_16x16x32_bf16 v[60:63], v[120:123], v[104:107], v[60:63]
    s_cbranch_vccnz L_m2rCf
L_m2dCf:
    ds_read_b128 v[84:87], v43 offset:10240
    v_mfma_f32_16x16x32_bf16 v[64:67], v[124:127], v[104:107], v[64:67]
    ds_read_b128 v[88:91], v43 offset:11264
    s_waitcnt lgkmcnt(8)
    v_mfma_f32_16x16x32_bf16 v[52:55], v[128:131], v[76:79], v[52:55]
    ds_read_b32 v108, v45 offset:76
    ds_read_b128 v[92:95], v43 offset:12288
    v_mfma_f32_16x16x32_bf16 v[56:59], v[132:135], v[76:79], v[56:59]
    ds_read_b128 v[96:99], v43 offset:13312
    s_waitcnt lgkmcnt(10)
    v_mfma_f32_16x16x32_bf16 v[60:63], v[128:131], v[80:83], v[60:63]
    ds_read_b64_tr_b16 v[216:217], v36 offset:0
    ds_read_b64_tr_b16 v[218:219], v36 offset:6144
    v_mfma_f32_16x16x32_bf16 v[64:67], v[132:135], v[80:83], v[64:67]
    ds_read_b64_tr_b16 v[220:221], v37 offset:0
    s_waitcnt lgkmcnt(7)
    v_mfma_f32_16x16x32_bf16 v[52:55], v[136:139], v[84:87], v[52:55]
    s_waitcnt lgkmcnt(5)
    v_cmp_eq_u32 vcc, 0, v108
    ds_read_b64_tr_b16 v[222:223], v37 offset:6144
    v_mfma_f32_16x16x32_bf16 v[56:59], v[140:143], v[84:87], v[56:59]
    ds_read_b64_tr_b16 v[224:225], v36 offset:8192
    v_mfma_f32_16x16x32_bf16 v[60:63], v[136:139], v[88:91], v[60:63]
    s_cbranch_vccnz L_m3rCf
L_m3dCf:
    ds_read_b128 v[100:103], v43 offset:14336
    v_mfma_f32_16x16x32_bf16 v[64:67], v[140:143], v[88:91], v[64:67]
    ds_read_b128 v[104:107], v43 offset:15360
    s_waitcnt lgkmcnt(8)
    v_mfma_f32_16x16x32_bf16 v[52:55], v[144:147], v[92:95], v[52:55]
    ds_read_b32 v108, v45 offset:80
    ds_read_b128 v[76:79], v43 offset:16384
    v_mfma_f32_16x16x32_bf16 v[56:59], v[148:151], v[92:95], v[56:59]
    ds_read_b128 v[80:83], v43 offset:17408
    s_waitcnt lgkmcnt(10)
    v_mfma_f32_16x16x32_bf16 v[60:63], v[144:147], v[96:99], v[60:63]
    ds_read_b64_tr_b16 v[226:227], v36 offset:14336
    ds_read_b64_tr_b16 v[228:229], v37 offset:8192
    v_mfma_f32_16x16x32_bf16 v[64:67], v[148:151], v[96:99], v[64:67]
    ds_read_b64_tr_b16 v[230:231], v37 offset:14336
    s_waitcnt lgkmcnt(7)
    v_mfma_f32_16x16x32_bf16 v[52:55], v[152:155], v[100:103], v[52:55]
    s_waitcnt lgkmcnt(5)
    v_cmp_eq_u32 vcc, 0, v108
    ds_read_b64_tr_b16 v[232:233], v36 offset:16384
    v_mfma_f32_16x16x32_bf16 v[56:59], v[156:159], v[100:103], v[56:59]
    ds_read_b64_tr_b16 v[234:235], v36 offset:22528
    v_mfma_f32_16x16x32_bf16 v[60:63], v[152:155], v[104:107], v[60:63]
    s_cbranch_vccnz L_m4rCf
L_m4dCf:
    ds_read_b128 v[84:87], v47 offset:0
    v_mfma_f32_16x16x32_bf16 v[64:67], v[156:159], v[104:107], v[64:67]
    ds_read_b128 v[88:91], v47 offset:2048
    s_waitcnt lgkmcnt(8)
    v_mfma_f32_16x16x32_bf16 v[52:55], v[160:163], v[76:79], v[52:55]
    ds_read_b32 v108, v45 offset:84
    ds_read_b128 v[92:95], v47 offset:4096
    v_mfma_f32_16x16x32_bf16 v[56:59], v[164:167], v[76:79], v[56:59]
    ds_read_b128 v[96:99], v47 offset:6144
    s_waitcnt lgkmcnt(10)
    v_mfma_f32_16x16x32_bf16 v[60:63], v[160:163], v[80:83], v[60:63]
    ds_read_b64_tr_b16 v[236:237], v37 offset:16384
    ds_read_b64_tr_b16 v[238:239], v37 offset:22528
    v_mfma_f32_16x16x32_bf16 v[64:67], v[164:167], v[80:83], v[64:67]
    ds_read_b64_tr_b16 v[240:241], v36 offset:24576
    s_waitcnt lgkmcnt(7)
    v_mfma_f32_16x16x32_bf16 v[52:55], v[168:171], v[84:87], v[52:55]
    s_waitcnt lgkmcnt(5)
    v_cmp_eq_u32 vcc, 0, v108
    ds_read_b64_tr_b16 v[242:243], v36 offset:30720
    v_mfma_f32_16x16x32_bf16 v[56:59], v[172:175], v[84:87], v[56:59]
    ds_read_b64_tr_b16 v[244:245], v37 offset:24576
    v_mfma_f32_16x16x32_bf16 v[60:63], v[168:171], v[88:91], v[60:63]
    s_cbranch_vccnz L_m5rCf
L_m5dCf:
    ds_read_b128 v[100:103], v47 offset:8192
    v_mfma_f32_16x16x32_bf16 v[64:67], v[172:175], v[88:91], v[64:67]
    ds_read_b128 v[104:107], v47 offset:10240
    s_waitcnt lgkmcnt(8)
    v_mfma_f32_16x16x32_bf16 v[52:55], v[176:179], v[92:95], v[52:55]
    ds_read_b32 v108, v45 offset:88
    ds_read_b128 v[76:79], v47 offset:12288
    v_mfma_f32_16x16x32_bf16 v[56:59], v[180:183], v[92:95], v[56:59]
    ds_read_b128 v[80:83], v44 offset:0
    s_waitcnt lgkmcnt(10)
    v_mfma_f32_16x16x32_bf16 v[60:63], v[176:179], v[96:99], v[60:63]
    ds_read_b64_tr_b16 v[246:247], v37 offset:30720
    ds_read_b64_tr_b16 v[248:249], v36 offset:32768
    v_mfma_f32_16x16x32_bf16 v[64:67], v[180:183], v[96:99], v[64:67]
    ds_read_b64_tr_b16 v[250:251], v36 offset:38912
    s_waitcnt lgkmcnt(7)
    v_mfma_f32_16x16x32_bf16 v[68:71], v[120:123], v[100:103], v[68:71]
    s_waitcnt lgkmcnt(5)
    v_cmp_eq_u32 vcc, 0, v108
    ds_read_b64_tr_b16 v[252:253], v37 offset:32768
    v_mfma_f32_16x16x32_bf16 v[72:75], v[124:127], v[100:103], v[72:75]
    ds_read_b64_tr_b16 v[254:255], v37 offset:38912
    v_mfma_f32_16x16x32_bf16 v[68:71], v[128:131], v[104:107], v[68:71]
    s_cbranch_vccnz L_m6rCf
L_m6dCf:
    ds_read_b128 v[84:87], v44 offset:2048
    v_mfma_f32_16x16x32_bf16 v[72:75], v[132:135], v[104:107], v[72:75]
    ds_read_b128 v[88:91], v44 offset:4096
    s_waitcnt lgkmcnt(8)
    v_mfma_f32_16x16x32_bf16 v[68:71], v[136:139], v[76:79], v[68:71]
    ds_read_b32 v108, v45 offset:92
    ds_read_b128 v[92:95], v44 offset:6144
    v_mfma_f32_16x16x32_bf16 v[72:75], v[140:143], v[76:79], v[72:75]
    ds_read_b128 v[96:99], v44 offset:8192
    s_waitcnt lgkmcnt(10)
    v_mfma_f32_16x16x32_bf16 v[68:71], v[144:147], v[80:83], v[68:71]
    v_mfma_f32_16x16x32_bf16 v[72:75], v[148:151], v[80:83], v[72:75]
    s_waitcnt lgkmcnt(4)
    v_mfma_f32_16x16x32_bf16 v[68:71], v[152:155], v[84:87], v[68:71]
    s_waitcnt lgkmcnt(2)
    v_cmp_eq_u32 vcc, 0, v108
    v_mfma_f32_16x16x32_bf16 v[72:75], v[156:159], v[84:87], v[72:75]
    v_mfma_f32_16x16x32_bf16 v[68:71], v[160:163], v[88:91], v[68:71]
    s_cbranch_vccnz L_m7rCf
L_m7dCf:
    ds_read_b128 v[100:103], v44 offset:10240
    v_mfma_f32_16x16x32_bf16 v[72:75], v[164:167], v[88:91], v[72:75]
    ds_read_b128 v[104:107], v44 offset:12288
    s_waitcnt lgkmcnt(3)
    v_mfma_f32_16x16x32_bf16 v[68:71], v[168:171], v[92:95], v[68:71]
    ds_read_b32 v108, v45 offset:96
    ds_read_b128 v[76:79], v44 offset:14336
    v_mfma_f32_16x16x32_bf16 v[72:75], v[172:175], v[92:95], v[72:75]
    ds_read_b128 v[80:83], v44 offset:16384
    s_waitcnt lgkmcnt(5)
    v_mfma_f32_16x16x32_bf16 v[68:71], v[176:179], v[96:99], v[68:71]
    v_mfma_f32_16x16x32_bf16 v[72:75], v[180:183], v[96:99], v[72:75]
    s_waitcnt lgkmcnt(4)
    v_mfma_f32_16x16x32_bf16 v[52:55], v[192:195], v[100:103], v[52:55]
    s_waitcnt lgkmcnt(2)
    v_cmp_eq_u32 vcc, 0, v108
    v_mfma_f32_16x16x32_bf16 v[56:59], v[196:199], v[100:103], v[56:59]
    v_mfma_f32_16x16x32_bf16 v[60:63], v[192:195], v[104:107], v[60:63]
    s_cbranch_vccnz L_m8rCf
L_m8dCf:
    ds_read_b128 v[84:87], v44 offset:18432
    v_mfma_f32_16x16x32_bf16 v[64:67], v[196:199], v[104:107], v[64:67]
    ds_read_b128 v[88:91], v44 offset:20480
    s_waitcnt lgkmcnt(3)
    v_mfma_f32_16x16x32_bf16 v[52:55], v[200:203], v[76:79], v[52:55]
    ds_read_b32 v108, v45 offset:100
    ds_read_b128 v[92:95], v44 offset:22528
    v_mfma_f32_16x16x32_bf16 v[56:59], v[204:207], v[76:79], v[56:59]
    ds_read_b128 v[96:99], v44 offset:24576
    s_waitcnt lgkmcnt(5)
    v_mfma_f32_16x16x32_bf16 v[60:63], v[200:203], v[80:83], v[60:63]
    v_mfma_f32_16x16x32_bf16 v[64:67], v[204:207], v[80:83], v[64:67]
    s_waitcnt lgkmcnt(4)
    v_mfma_f32_16x16x32_bf16 v[52:55], v[208:211], v[84:87], v[52:55]
    s_waitcnt lgkmcnt(2)
    v_cmp_eq_u32 vcc, 0, v108
    v_mfma_f32_16x16x32_bf16 v[56:59], v[212:215], v[84:87], v[56:59]
    v_mfma_f32_16x16x32_bf16 v[60:63], v[208:211], v[88:91], v[60:63]
    s_cbranch_vccnz L_m9rCf
L_m9dCf:
    ds_read_b128 v[100:103], v44 offset:26624
    v_mfma_f32_16x16x32_bf16 v[64:67], v[212:215], v[88:91], v[64:67]
    ds_read_b128 v[104:107], v44 offset:28672
    s_waitcnt lgkmcnt(3)
    v_mfma_f32_16x16x32_bf16 v[52:55], v[216:219], v[92:95], v[52:55]
    ds_read_b32 v108, v45 offset:104
    ds_read_b128 v[76:79], v44 offset:30720
    v_mfma_f32_16x16x32_bf16 v[56:59], v[220:223], v[92:95], v[56:59]
    ds_read_b128 v[80:83], v44 offset:32768
    s_waitcnt lgkmcnt(5)
    v_mfma_f32_16x16x32_bf16 v[60:63], v[216:219], v[96:99], v[60:63]
    v_mfma_f32_16x16x32_bf16 v[64:67], v[220:223], v[96:99], v[64:67]
    s_waitcnt lgkmcnt(4)
    v_mfma_f32_16x16x32_bf16 v[52:55], v[224:227], v[100:103], v[52:55]
    s_waitcnt lgkmcnt(2)
    v_cmp_eq_u32 vcc, 0, v108
    v_mfma_f32_16x16x32_bf16 v[56:59], v[228:231], v[100:103], v[56:59]
    v_mfma_f32_16x16x32_bf16 v[60:63], v[224:227], v[104:107], v[60:63]
    s_cbranch_vccnz L_m10rCf
L_m10dCf:
    ds_read_b128 v[84:87], v44 offset:34816
    v_mfma_f32_16x16x32_bf16 v[64:67], v[228:231], v[104:107], v[64:67]
    ds_read_b128 v[88:91], v47 offset:15360
    s_waitcnt lgkmcnt(3)
    v_mfma_f32_16x16x32_bf16 v[52:55], v[232:235], v[76:79], v[52:55]
    ds_read_b32 v108, v45 offset:108
    ds_read_b128 v[92:95], v47 offset:17408
    v_mfma_f32_16x16x32_bf16 v[56:59], v[236:239], v[76:79], v[56:59]
    ds_read_b128 v[96:99], v47 offset:19456
    s_waitcnt lgkmcnt(5)
    v_mfma_f32_16x16x32_bf16 v[60:63], v[232:235], v[80:83], v[60:63]
    v_mfma_f32_16x16x32_bf16 v[64:67], v[236:239], v[80:83], v[64:67]
    s_waitcnt lgkmcnt(4)
    v_mfma_f32_16x16x32_bf16 v[52:55], v[240:243], v[84:87], v[52:55]
    s_waitcnt lgkmcnt(2)
    v_cmp_eq_u32 vcc, 0, v108
    v_mfma_f32_16x16x32_bf16 v[56:59], v[244:247], v[84:87], v[56:59]
    v_mfma_f32_16x16x32_bf16 v[60:63], v[240:243], v[88:91], v[60:63]
    s_cbranch_vccnz L_m11rCf
L_m11dCf:
    ds_read_b128 v[100:103], v47 offset:21504
    v_mfma_f32_16x16x32_bf16 v[64:67], v[244:247], v[88:91], v[64:67]
    ds_read_b128 v[104:107], v47 offset:25600
    s_waitcnt lgkmcnt(3)
    v_mfma_f32_16x16x32_bf16 v[52:55], v[248:251], v[92:95], v[52:55]
    ds_read_b32 v108, v45 offset:112
    ds_read_b128 v[76:79], v47 offset:27648
    v_mfma_f32_16x16x32_bf16 v[56:59], v[252:255], v[92:95], v[56:59]
    ds_read_b128 v[80:83], v47 offset:33792
    s_waitcnt lgkmcnt(5)
    v_mfma_f32_16x16x32_bf16 v[60:63], v[248:251], v[96:99], v[60:63]
    v_mfma_f32_16x16x32_bf16 v[64:67], v[252:255], v[96:99], v[64:67]
    s_waitcnt lgkmcnt(4)
    v_mfma_f32_16x16x32_bf16 v[68:71], v[192:195], v[100:103], v[68:71]
    s_waitcnt lgkmcnt(2)
    v_cmp_eq_u32 vcc, 0, v108
    v_mfma_f32_16x16x32_bf16 v[72:75], v[196:199], v[100:103], v[72:75]
    v_mfma_f32_16x16x32_bf16 v[68:71], v[200:203], v[104:107], v[68:71]
    s_cbranch_vccnz L_m12rCf
L_m12dCf:
    ds_read_b128 v[84:87], v47 offset:35840
    v_mfma_f32_16x16x32_bf16 v[72:75], v[204:207], v[104:107], v[72:75]
    ds_read_b128 v[88:91], v47 offset:41984
    buffer_load_dword v109, v31, s[20:23], 0 offen sc1
    s_waitcnt lgkmcnt(3)
    v_mfma_f32_16x16x32_bf16 v[68:71], v[208:211], v[76:79], v[68:71]
    ds_read_b128 v[92:95], v47 offset:44032
    ds_read_b128 v[96:99], v47 offset:50176
    v_mfma_f32_16x16x32_bf16 v[72:75], v[212:215], v[76:79], v[72:75]
    v_cvt_pk_bf16_f32 v52, v52, v53
    s_waitcnt lgkmcnt(4)
    v_mfma_f32_16x16x32_bf16 v[68:71], v[216:219], v[80:83], v[68:71]
    v_cvt_pk_bf16_f32 v53, v54, v55
    v_cvt_pk_bf16_f32 v56, v56, v57
    v_mfma_f32_16x16x32_bf16 v[72:75], v[220:223], v[80:83], v[72:75]
    v_cvt_pk_bf16_f32 v57, v58, v59
    s_waitcnt lgkmcnt(3)
    v_mfma_f32_16x16x32_bf16 v[68:71], v[224:227], v[84:87], v[68:71]
    ds_write_b64 v38, v[52:53] offset:0
    v_mfma_f32_16x16x32_bf16 v[72:75], v[228:231], v[84:87], v[72:75]
    ds_write_b64 v48, v[56:57] offset:0
    s_waitcnt lgkmcnt(4)
    v_mfma_f32_16x16x32_bf16 v[68:71], v[232:235], v[88:91], v[68:71]
    ds_read_b128 v[112:115], v39 offset:0
    v_cvt_pk_bf16_f32 v60, v60, v61
    v_mfma_f32_16x16x32_bf16 v[72:75], v[236:239], v[88:91], v[72:75]
    v_cvt_pk_bf16_f32 v61, v62, v63
    s_waitcnt lgkmcnt(4)
    v_mfma_f32_16x16x32_bf16 v[68:71], v[240:243], v[92:95], v[68:71]
    v_cvt_pk_bf16_f32 v64, v64, v65
    v_cvt_pk_bf16_f32 v65, v66, v67
    v_mfma_f32_16x16x32_bf16 v[72:75], v[244:247], v[92:95], v[72:75]
    ds_write_b64 v38, v[60:61] offset:0
    s_waitcnt lgkmcnt(4)
    v_mfma_f32_16x16x32_bf16 v[68:71], v[248:251], v[96:99], v[68:71]
    ds_write_b64 v48, v[64:65] offset:0
    v_mfma_f32_16x16x32_bf16 v[72:75], v[252:255], v[96:99], v[72:75]
    ds_read_b128 v[116:119], v39 offset:0
    s_waitcnt vmcnt(0)
    v_cmp_ne_u32 vcc, 0, v109
    s_nop 2
    v_cvt_pk_bf16_f32 v68, v68, v69
    v_cvt_pk_bf16_f32 v69, v70, v71
    v_cvt_pk_bf16_f32 v72, v72, v73
    v_cvt_pk_bf16_f32 v73, v74, v75
    s_andn2_b32 s42, 0x3ffff, vcc_lo
    s_cbranch_scc1 L_mdrCf
L_mddCf:
    s_waitcnt lgkmcnt(3)
    buffer_store_dwordx4 v[112:115], v40, s[16:19], 0 offen nt
    ds_write_b64 v38, v[68:69] offset:0
    ds_write_b64 v48, v[72:73] offset:0
    ds_read_b128 v[120:123], v39 offset:0
    s_waitcnt lgkmcnt(3)
    buffer_store_dwordx4 v[116:119], v41, s[16:19], 0 offen nt
    s_waitcnt lgkmcnt(0)
    buffer_store_dwordx4 v[120:123], v42, s[16:19], 0 offen nt
L_fin:
L_end:
    s_endpgm
    .p2alignl 12, 0xbf810000
L_attnL:
    s_cmp_lg_u32 s39, s3
    s_cbranch_scc1 L_attnLq
L_attnLf:
    s_waitcnt vmcnt(1)
    s_barrier
    ds_read_b128 v[112:115], v49 offset:0
    ds_read_b128 v[116:119], v49 offset:1024
    ds_read_b128 v[120:123], v49 offset:2048
    ds_read_b128 v[128:131], v50 offset:2048
    ds_read_b128 v[124:127], v49 offset:3072
    ds_read_b128 v[132:135], v50 offset:3072
    ds_read_b128 v[196:199], v49 offset:4096
    ds_read_b128 v[200:203], v50 offset:4096
    v_mov_b32 v210, 0
    v_mov_b32 v206, 0
    v_mov_b32 v218, 0
    v_mov_b32 v222, 0
    v_mov_b32 v225, 0
    ds_read_b128 v[192:195], v49 offset:5120
    ds_read_b128 v[52:55], v50 offset:5120
    v_mov_b32 v213, 0
    v_mov_b32 v58, 0
    s_waitcnt lgkmcnt(9)
    v_and_b32 v136, v13, v112
    v_and_b32 v137, v14, v113
    s_waitcnt lgkmcnt(8)
    v_and_b32 v148, v19, v118
    v_and_b32 v149, v20, v119
    v_xor_b32 v150, v148, v118
    v_xor_b32 v151, v149, v119
    s_waitcnt lgkmcnt(6)
    v_mfma_f32_16x16x16_bf16 v[152:155], v[128:129], v[136:137], v[6:9]
    v_and_b32 v140, v15, v114
    v_and_b32 v141, v16, v115
    v_mfma_f32_16x16x16_bf16 v[156:159], v[120:121], v[136:137], v[2:5]
    v_and_b32 v144, v17, v116
    v_and_b32 v145, v18, v117
    s_waitcnt lgkmcnt(4)
    v_mfma_f32_16x16x16_bf16 v[184:187], v[134:135], v[150:151], v[6:9]
    v_xor_b32 v138, v136, v112
    v_xor_b32 v139, v137, v113
    v_mfma_f32_16x16x16_bf16 v[188:191], v[126:127], v[150:151], v[2:5]
    v_xor_b32 v142, v140, v114
    v_xor_b32 v143, v141, v115
    v_xor_b32 v146, v144, v116
    v_xor_b32 v147, v145, v117
    v_max3_f32 v76, v153, v156, v157
    v_max3_f32 v77, v155, v158, v159
    v_mfma_f32_16x16x32_bf16 v[160:163], v[128:131], v[138:141], v[6:9]
    buffer_store_dwordx2 v[76:77], v27, s[64:67], 0 offen
    v_max3_f32 v84, v185, v188, v189
    v_max3_f32 v85, v187, v190, v191
    v_mfma_f32_16x16x32_bf16 v[164:167], v[120:123], v[138:141], v[2:5]
    buffer_store_dwordx2 v[84:85], v28, s[64:67], 0 offen
    s_waitcnt lgkmcnt(0)
    v_and_b32 v208, v23, v198
    v_mfma_f32_16x16x32_bf16 v[168:171], v[130:133], v[142:145], v[6:9]
    v_and_b32 v209, v23, v199
    v_and_b32 v211, v23, v203
    v_mfma_f32_16x16x32_bf16 v[172:175], v[122:125], v[142:145], v[2:5]
    v_and_b32 v204, v22, v196
    v_and_b32 v205, v22, v197
    v_mfma_f32_16x16x32_bf16 v[176:179], v[132:135], v[146:149], v[6:9]
    v_max3_f32 v78, v161, v164, v165
    v_max3_f32 v79, v163, v166, v167
    v_mfma_f32_16x16x32_bf16 v[180:183], v[124:127], v[146:149], v[2:5]
    v_max_f32 v104, v78, v79
    v_and_b32 v207, v22, v201
    v_max3_f32 v80, v169, v172, v173
    v_max3_f32 v81, v171, v174, v175
    v_max_f32 v106, v80, v81
    v_xor_b32 v202, v209, v199
    v_xor_b32 v200, v208, v198
    v_permlane16_swap_b32 v104, v106
    v_max3_f32 v82, v177, v180, v181
    v_max3_f32 v83, v179, v182, v183
    v_max_f32 v108, v82, v83
    v_max_f32 v110, v82, v83
    v_max_f32 v104, v104, v106
    v_xor_b32 v203, v211, v203
    v_permlane16_swap_b32 v108, v110
    v_max_f32 v108, v108, v110
    v_xor_b32 v196, v204, v196
    v_xor_b32 v197, v205, v197
    v_permlane32_swap_b32 v104, v108
    v_max_f32 v104, v104, v108
    v_mul_f32 v108, s46, v104
    v_mul_f32 v104, s46, v104
    v_xor_b32 v199, v207, v201
    v_and_b32 v214, v24, v195
    v_permlane32_swap_b32 v104, v108
    v_mov_b32 v106, v104
    v_pk_fma_f32 v[82:83], v[82:83], s[46:47], v[108:109] op_sel:[0,0,0] op_sel_hi:[1,1,0] neg_lo:[0,0,1] neg_hi:[0,0,1]
    v_exp_f32 v82, v82
    v_permlane16_swap_b32 v104, v106
    v_pk_fma_f32 v[78:79], v[78:79], s[46:47], v[104:105] op_sel:[0,0,0] op_sel_hi:[1,1,0] neg_lo:[0,0,1] neg_hi:[0,0,1]
    v_pk_fma_f32 v[80:81], v[80:81], s[46:47], v[106:107] op_sel:[0,0,0] op_sel_hi:[1,1,0] neg_lo:[0,0,1] neg_hi:[0,0,1]
    v_exp_f32 v78, v78
    v_exp_f32 v79, v79
    v_exp_f32 v80, v80
    v_exp_f32 v81, v81
    v_exp_f32 v83, v83
    v_add_f32 v104, v78, v79
    v_add_f32 v106, v80, v81
    v_add_f32 v108, v82, v83
    v_add_f32 v110, v82, v83
    v_permlane16_swap_b32 v104, v106
    v_add_f32 v104, v104, v106
    buffer_load_dwordx2 v[86:87], v29, s[64:67], 0 offen sc1
    buffer_load_dwordx2 v[88:89], v30, s[64:67], 0 offen sc1
    v_permlane16_swap_b32 v108, v110
    v_add_f32 v108, v108, v110
    v_xor_b32 v54, v214, v195
    v_and_b32 v56, v21, v192
    v_permlane32_swap_b32 v104, v108
    v_add_f32 v104, v104, v108
    v_rcp_f32 v104, v104
    v_and_b32 v57, v21, v193
    v_mov_b32 v108, v104
    v_and_b32 v59, v21, v53
    v_and_b32 v212, v24, v194
    v_permlane32_swap_b32 v104, v108
    v_mov_b32 v106, v104
    v_pk_mul_f32 v[82:83], v[82:83], v[108:109] op_sel:[0,0] op_sel_hi:[1,0]
    v_cvt_pk_bf16_f32 v82, v82, v83
    v_permlane16_swap_b32 v104, v106
    v_pk_mul_f32 v[78:79], v[78:79], v[104:105] op_sel:[0,0] op_sel_hi:[1,0]
    v_pk_mul_f32 v[80:81], v[80:81], v[106:107] op_sel:[0,0] op_sel_hi:[1,0]
    v_cvt_pk_bf16_f32 v78, v78, v79
    v_cvt_pk_bf16_f32 v80, v80, v81
    v_and_b32 v216, v10, v78
    v_and_b32 v217, v11, v78
    v_and_b32 v219, v12, v78
    v_and_b32 v220, v10, v80
    v_and_b32 v221, v11, v80
    v_and_b32 v223, v12, v80
    v_mfma_f32_16x16x32_bf16 v[228:231], v[204:207], v[216:219], 0
    v_and_b32 v224, v10, v82
    v_and_b32 v226, v11, v82
    v_mfma_f32_16x16x32_bf16 v[232:235], v[208:211], v[220:223], 0
    v_and_b32 v227, v12, v82
    v_and_b32 v215, v24, v55
    v_mfma_f32_16x16x32_bf16 v[228:231], v[196:199], v[220:223], v[228:231]
    v_xor_b32 v192, v56, v192
    v_xor_b32 v193, v57, v193
    v_mfma_f32_16x16x32_bf16 v[232:235], v[200:203], v[224:227], v[232:235]
    v_xor_b32 v195, v59, v53
    v_xor_b32 v52, v212, v194
    v_mfma_f32_16x16x32_bf16 v[72:75], v[212:215], v[224:227], 0
    v_xor_b32 v55, v215, v55
    s_nop 0
    v_cvt_pk_bf16_f32 v96, v228, v229
    v_cvt_pk_bf16_f32 v97, v230, v231
    v_mfma_f32_16x16x32_bf16 v[68:71], v[192:195], v[216:219], 0
    v_cvt_pk_bf16_f32 v98, v232, v233
    v_cvt_pk_bf16_f32 v99, v234, v235
    buffer_store_dwordx4 v[96:99], v25, s[4:7], 0 offen
    s_waitcnt vmcnt(1)
    v_max3_u32 v94, v86, v87, v88
    v_max_u32 v94, v94, v89
    v_cmp_eq_u32 vcc, -1, v94
    s_cbranch_vccnz L_c1rLf
L_c1dLf:
    v_pk_add_f32 v[76:77], v[76:77], v[86:87]
    v_pk_add_f32 v[84:85], v[84:85], v[88:89]
    v_max_f32 v104, v76, v77
    v_max_f32 v106, v84, v85
    v_mov_b32 v62, 0
    v_mov_b32 v65, 0
    v_permlane16_swap_b32 v104, v106
    v_max_f32 v104, v104, v106
    v_mov_b32 v106, v104
    s_nop 1
    v_permlane32_swap_b32 v104, v106
    v_max_f32 v104, v104, v106
    s_waitcnt vmcnt(0)
    buffer_store_dword v1, v32, s[20:23], 0 offen offset:36
    v_mul_f32 v106, s46, v104
    v_mul_f32 v104, s46, v104
    s_nop 1
    v_permlane16_swap_b32 v104, v106
    v_pk_fma_f32 v[76:77], v[76:77], s[46:47], v[104:105] op_sel:[0,0,0] op_sel_hi:[1,1,0] neg_lo:[0,0,1] neg_hi:[0,0,1]
    v_pk_fma_f32 v[84:85], v[84:85], s[46:47], v[106:107] op_sel:[0,0,0] op_sel_hi:[1,1,0] neg_lo:[0,0,1] neg_hi:[0,0,1]
    v_exp_f32 v76, v76
    v_exp_f32 v77, v77
    v_exp_f32 v84, v84
    v_exp_f32 v85, v85
    v_add_f32 v104, v76, v77
    v_add_f32 v106, v84, v85
    s_nop 1
    v_permlane16_swap_b32 v104, v106
    v_add_f32 v104, v104, v106
    v_mov_b32 v106, v104
    s_nop 1
    v_permlane32_swap_b32 v104, v106
    v_add_f32 v104, v104, v106
    v_rcp_f32 v104, v104
    s_nop 0
    v_mov_b32 v106, v104
    s_nop 1
    v_permlane16_swap_b32 v104, v106
    v_pk_mul_f32 v[76:77], v[76:77], v[104:105] op_sel:[0,0] op_sel_hi:[1,0]
    v_pk_mul_f32 v[84:85], v[84:85], v[106:107] op_sel:[0,0] op_sel_hi:[1,0]
    v_cvt_pk_bf16_f32 v76, v76, v77
    v_cvt_pk_bf16_f32 v84, v84, v85
    v_and_b32 v60, v10, v76
    v_and_b32 v61, v11, v76
    v_and_b32 v63, v12, v76
    v_and_b32 v64, v10, v84
    v_and_b32 v66, v11, v84
    v_and_b32 v67, v12, v84
    v_mfma_f32_16x16x32_bf16 v[68:71], v[56:59], v[60:63], v[68:71]
    s_nop 0
    v_mfma_f32_16x16x32_bf16 v[72:75], v[52:55], v[64:67], v[72:75]
    s_nop 5
    v_cvt_pk_bf16_f32 v100, v68, v69
    v_cvt_pk_bf16_f32 v101, v70, v71
    v_cvt_pk_bf16_f32 v102, v72, v73
    v_cvt_pk_bf16_f32 v103, v74, v75
    buffer_store_dwordx4 v[100:103], v31, s[64:67], s48 offen offset:1024 nt
    ds_write_b128 v51, v[96:99]
    ds_write_b128 v51, v[100:103] offset:3072
    s_waitcnt lgkmcnt(0)
    s_barrier
    s_waitcnt vmcnt(0)
    buffer_store_dword v1, v32, s[20:23], 0 offen offset:72
    s_endpgm
L_c1rLf:
    s_add_u32 s40, s40, 1
    s_cmp_ge_u32 s40, 0x40000
    s_cbranch_scc1 L_c1dLf
    buffer_load_dwordx2 v[86:87], v29, s[64:67], 0 offen sc1
    buffer_load_dwordx2 v[88:89], v30, s[64:67], 0 offen sc1
    s_waitcnt vmcnt(2)
    buffer_store_dword v1, v32, s[20:23], 0 offen offset:36
    s_waitcnt vmcnt(1)
    v_max3_u32 v94, v86, v87, v88
    v_max_u32 v94, v94, v89
    v_cmp_eq_u32 vcc, -1, v94
    s_cbranch_vccnz L_c1rLf
    s_branch L_c1dLf
L_c1rCf:
    s_add_u32 s40, s40, 1
    s_cmp_ge_u32 s40, 0x40000
    s_cbranch_scc1 L_c1dCf
    buffer_load_dwordx2 v[86:87], v29, s[4:7], 0 offen sc1
    buffer_load_dwordx2 v[88:89], v30, s[4:7], 0 offen sc1
    s_waitcnt vmcnt(0)
    v_max3_u32 v94, v86, v87, v88
    v_max_u32 v94, v94, v89
    v_cmp_eq_u32 vcc, -1, v94
    s_cbranch_vccnz L_c1rCf
    s_branch L_c1dCf
L_worCf:
    s_add_u32 s40, s40, 1
    s_cmp_ge_u32 s40, 0x40000
    s_cbranch_scc1 L_wodCf
    ds_read_b32 v95, v45 offset:4
    s_waitcnt lgkmcnt(0)
    v_cmp_gt_u32 vcc, 2, v95
    s_cbranch_vccnz L_worCf
    s_branch L_wodCf
L_m1rCf:
    ds_read_b32 v108, v45 offset:68
    s_add_u32 s40, s40, 1
    s_cmp_ge_u32 s40, 0x40000
    s_cbranch_scc1 L_m1dCf
    s_waitcnt lgkmcnt(0)
    v_cmp_eq_u32 vcc, 0, v108
    s_cbranch_vccnz L_m1rCf
    s_branch L_m1dCf
L_m2rCf:
    ds_read_b32 v108, v45 offset:72
    s_add_u32 s40, s40, 1
    s_cmp_ge_u32 s40, 0x40000
    s_cbranch_scc1 L_m2dCf
    s_waitcnt lgkmcnt(0)
    v_cmp_eq_u32 vcc, 0, v108
    s_cbranch_vccnz L_m2rCf
    s_branch L_m2dCf
L_m3rCf:
    ds_read_b32 v108, v45 offset:76
    s_add_u32 s40, s40, 1
    s_cmp_ge_u32 s40, 0x40000
    s_cbranch_scc1 L_m3dCf
    s_waitcnt lgkmcnt(0)
    v_cmp_eq_u32 vcc, 0, v108
    s_cbranch_vccnz L_m3rCf
    s_branch L_m3dCf
L_m4rCf:
    ds_read_b32 v108, v45 offset:80
    s_add_u32 s40, s40, 1
    s_cmp_ge_u32 s40, 0x40000
    s_cbranch_scc1 L_m4dCf
    s_waitcnt lgkmcnt(0)
    v_cmp_eq_u32 vcc, 0, v108
    s_cbranch_vccnz L_m4rCf
    s_branch L_m4dCf
L_m5rCf:
    ds_read_b32 v108, v45 offset:84
    s_add_u32 s40, s40, 1
    s_cmp_ge_u32 s40, 0x40000
    s_cbranch_scc1 L_m5dCf
    s_waitcnt lgkmcnt(0)
    v_cmp_eq_u32 vcc, 0, v108
    s_cbranch_vccnz L_m5rCf
    s_branch L_m5dCf
L_m6rCf:
    ds_read_b32 v108, v45 offset:88
    s_add_u32 s40, s40, 1
    s_cmp_ge_u32 s40, 0x40000
    s_cbranch_scc1 L_m6dCf
    s_waitcnt lgkmcnt(0)
    v_cmp_eq_u32 vcc, 0, v108
    s_cbranch_vccnz L_m6rCf
    s_branch L_m6dCf
L_m7rCf:
    ds_read_b32 v108, v45 offset:92
    s_add_u32 s40, s40, 1
    s_cmp_ge_u32 s40, 0x40000
    s_cbranch_scc1 L_m7dCf
    s_waitcnt lgkmcnt(0)
    v_cmp_eq_u32 vcc, 0, v108
    s_cbranch_vccnz L_m7rCf
    s_branch L_m7dCf
L_m8rCf:
    ds_read_b32 v108, v45 offset:96
    s_add_u32 s40, s40, 1
    s_cmp_ge_u32 s40, 0x40000
    s_cbranch_scc1 L_m8dCf
    s_waitcnt lgkmcnt(0)
    v_cmp_eq_u32 vcc, 0, v108
    s_cbranch_vccnz L_m8rCf
    s_branch L_m8dCf
L_m9rCf:
    ds_read_b32 v108, v45 offset:100
    s_add_u32 s40, s40, 1
    s_cmp_ge_u32 s40, 0x40000
    s_cbranch_scc1 L_m9dCf
    s_waitcnt lgkmcnt(0)
    v_cmp_eq_u32 vcc, 0, v108
    s_cbranch_vccnz L_m9rCf
    s_branch L_m9dCf
L_m10rCf:
    ds_read_b32 v108, v45 offset:104
    s_add_u32 s40, s40, 1
    s_cmp_ge_u32 s40, 0x40000
    s_cbranch_scc1 L_m10dCf
    s_waitcnt lgkmcnt(0)
    v_cmp_eq_u32 vcc, 0, v108
    s_cbranch_vccnz L_m10rCf
    s_branch L_m10dCf
L_m11rCf:
    ds_read_b32 v108, v45 offset:108
    s_add_u32 s40, s40, 1
    s_cmp_ge_u32 s40, 0x40000
    s_cbranch_scc1 L_m11dCf
    s_waitcnt lgkmcnt(0)
    v_cmp_eq_u32 vcc, 0, v108
    s_cbranch_vccnz L_m11rCf
    s_branch L_m11dCf
L_m12rCf:
    ds_read_b32 v108, v45 offset:112
    s_add_u32 s40, s40, 1
    s_cmp_ge_u32 s40, 0x40000
    s_cbranch_scc1 L_m12dCf
    s_waitcnt lgkmcnt(0)
    v_cmp_eq_u32 vcc, 0, v108
    s_cbranch_vccnz L_m12rCf
    s_branch L_m12dCf
L_mdrCf:
    buffer_load_dword v109, v31, s[20:23], 0 offen sc1
    s_add_u32 s40, s40, 1
    s_cmp_ge_u32 s40, 0x40000
    s_cbranch_scc1 L_mddCf
    s_waitcnt vmcnt(0)
    v_cmp_ne_u32 vcc, 0, v109
    s_nop 0
    s_andn2_b32 s42, 0x3ffff, vcc_lo
    s_cbranch_scc1 L_mdrCf
    s_branch L_mddCf
L_attnLs:
    s_waitcnt vmcnt(1)
    s_barrier
    ds_read_b128 v[112:115], v49 offset:0
    ds_read_b128 v[116:119], v49 offset:1024
    ds_read_b128 v[120:123], v49 offset:2048
    ds_read_b128 v[128:131], v50 offset:2048
    ds_read_b128 v[124:127], v49 offset:3072
    ds_read_b128 v[132:135], v50 offset:3072
    ds_read_b128 v[196:199], v49 offset:4096
    ds_read_b128 v[200:203], v50 offset:4096
    v_mov_b32 v210, 0
    v_mov_b32 v206, 0
    v_mov_b32 v218, 0
    v_mov_b32 v222, 0
    v_mov_b32 v225, 0
    ds_read_b128 v[192:195], v49 offset:5120
    ds_read_b128 v[52:55], v50 offset:5120
    v_mov_b32 v213, 0
    v_mov_b32 v58, 0
    s_waitcnt lgkmcnt(9)
    v_and_b32 v136, v13, v112
    v_and_b32 v137, v14, v113
    s_waitcnt lgkmcnt(8)
    v_and_b32 v148, v19, v118
    v_and_b32 v149, v20, v119
    v_xor_b32 v150, v148, v118
    v_xor_b32 v151, v149, v119
    s_waitcnt lgkmcnt(6)
    v_mfma_f32_16x16x16_bf16 v[152:155], v[128:129], v[136:137], v[6:9]
    v_and_b32 v140, v15, v114
    v_and_b32 v141, v16, v115
    v_mfma_f32_16x16x16_bf16 v[156:159], v[120:121], v[136:137], v[2:5]
    v_and_b32 v144, v17, v116
    v_and_b32 v145, v18, v117
    s_waitcnt lgkmcnt(4)
    v_mfma_f32_16x16x16_bf16 v[184:187], v[134:135], v[150:151], v[6:9]
    v_xor_b32 v138, v136, v112
    v_xor_b32 v139, v137, v113
    v_mfma_f32_16x16x16_bf16 v[188:191], v[126:127], v[150:151], v[2:5]
    v_xor_b32 v142, v140, v114
    v_xor_b32 v143, v141, v115
    v_max3_f32 v76, v153, v156, v157
    v_max3_f32 v77, v155, v158, v159
    buffer_store_dwordx2 v[76:77], v27, s[64:67], 0 offen sc1
    v_xor_b32 v146, v144, v116
    v_xor_b32 v147, v145, v117
    v_mfma_f32_16x16x32_bf16 v[160:163], v[128:131], v[138:141], v[6:9]
    v_max3_f32 v84, v185, v188, v189
    v_max3_f32 v85, v187, v190, v191
    buffer_store_dwordx2 v[84:85], v28, s[64:67], 0 offen sc1
    v_mfma_f32_16x16x32_bf16 v[164:167], v[120:123], v[138:141], v[2:5]
    s_waitcnt lgkmcnt(0)
    v_and_b32 v208, v23, v198
    v_and_b32 v209, v23, v199
    v_mfma_f32_16x16x32_bf16 v[168:171], v[130:133], v[142:145], v[6:9]
    v_and_b32 v211, v23, v203
    v_and_b32 v204, v22, v196
    v_mfma_f32_16x16x32_bf16 v[172:175], v[122:125], v[142:145], v[2:5]
    v_and_b32 v205, v22, v197
    v_and_b32 v207, v22, v201
    v_mfma_f32_16x16x32_bf16 v[176:179], v[132:135], v[146:149], v[6:9]
    v_max3_f32 v78, v161, v164, v165
    v_max3_f32 v79, v163, v166, v167
    v_mfma_f32_16x16x32_bf16 v[180:183], v[124:127], v[146:149], v[2:5]
    v_max_f32 v104, v78, v79
    v_xor_b32 v202, v209, v199
    v_max3_f32 v80, v169, v172, v173
    v_max3_f32 v81, v171, v174, v175
    v_max_f32 v106, v80, v81
    v_xor_b32 v200, v208, v198
    s_waitcnt vmcnt(0)
    buffer_store_dword v1, v32, s[20:23], 0 offen offset:0 sc1
    v_permlane16_swap_b32 v104, v106
    v_max3_f32 v82, v177, v180, v181
    v_max3_f32 v83, v179, v182, v183
    v_max_f32 v108, v82, v83
    v_max_f32 v110, v82, v83
    v_max_f32 v104, v104, v106
    v_xor_b32 v203, v211, v203
    v_permlane16_swap_b32 v108, v110
    v_max_f32 v108, v108, v110
    v_xor_b32 v196, v204, v196
    v_xor_b32 v197, v205, v197
    v_permlane32_swap_b32 v104, v108
    v_max_f32 v104, v104, v108
    v_mul_f32 v108, s46, v104
    v_mul_f32 v104, s46, v104
    v_xor_b32 v199, v207, v201
    v_and_b32 v214, v24, v195
    v_permlane32_swap_b32 v104, v108
    v_mov_b32 v106, v104
    v_pk_fma_f32 v[82:83], v[82:83], s[46:47], v[108:109] op_sel:[0,0,0] op_sel_hi:[1,1,0] neg_lo:[0,0,1] neg_hi:[0,0,1]
    v_exp_f32 v82, v82
    v_permlane16_swap_b32 v104, v106
    v_pk_fma_f32 v[78:79], v[78:79], s[46:47], v[104:105] op_sel:[0,0,0] op_sel_hi:[1,1,0] neg_lo:[0,0,1] neg_hi:[0,0,1]
    v_pk_fma_f32 v[80:81], v[80:81], s[46:47], v[106:107] op_sel:[0,0,0] op_sel_hi:[1,1,0] neg_lo:[0,0,1] neg_hi:[0,0,1]
    v_exp_f32 v78, v78
    v_exp_f32 v79, v79
    v_exp_f32 v80, v80
    v_exp_f32 v81, v81
    v_exp_f32 v83, v83
    v_add_f32 v104, v78, v79
    v_add_f32 v106, v80, v81
    v_add_f32 v108, v82, v83
    v_add_f32 v110, v82, v83
    v_permlane16_swap_b32 v104, v106
    v_add_f32 v104, v104, v106
    buffer_load_dword v94, v33, s[20:23], 0 offen sc1
    v_permlane16_swap_b32 v108, v110
    v_add_f32 v108, v108, v110
    v_xor_b32 v54, v214, v195
    v_and_b32 v56, v21, v192
    v_permlane32_swap_b32 v104, v108
    v_add_f32 v104, v104, v108
    v_rcp_f32 v104, v104
    v_and_b32 v57, v21, v193
    v_mov_b32 v108, v104
    v_and_b32 v59, v21, v53
    v_and_b32 v212, v24, v194
    v_permlane32_swap_b32 v104, v108
    v_mov_b32 v106, v104
    v_pk_mul_f32 v[82:83], v[82:83], v[108:109] op_sel:[0,0] op_sel_hi:[1,0]
    v_cvt_pk_bf16_f32 v82, v82, v83
    v_permlane16_swap_b32 v104, v106
    v_pk_mul_f32 v[78:79], v[78:79], v[104:105] op_sel:[0,0] op_sel_hi:[1,0]
    v_pk_mul_f32 v[80:81], v[80:81], v[106:107] op_sel:[0,0] op_sel_hi:[1,0]
    v_cvt_pk_bf16_f32 v78, v78, v79
    v_cvt_pk_bf16_f32 v80, v80, v81
    v_and_b32 v216, v10, v78
    v_and_b32 v217, v11, v78
    v_and_b32 v219, v12, v78
    v_and_b32 v220, v10, v80
    v_and_b32 v221, v11, v80
    v_and_b32 v223, v12, v80
    v_mfma_f32_16x16x32_bf16 v[228:231], v[204:207], v[216:219], 0
    v_and_b32 v224, v10, v82
    v_and_b32 v226, v11, v82
    v_mfma_f32_16x16x32_bf16 v[232:235], v[208:211], v[220:223], 0
    v_and_b32 v227, v12, v82
    v_and_b32 v215, v24, v55
    v_mfma_f32_16x16x32_bf16 v[228:231], v[196:199], v[220:223], v[228:231]
    v_xor_b32 v192, v56, v192
    v_xor_b32 v193, v57, v193
    v_mfma_f32_16x16x32_bf16 v[232:235], v[200:203], v[224:227], v[232:235]
    v_xor_b32 v195, v59, v53
    v_xor_b32 v52, v212, v194
    v_mfma_f32_16x16x32_bf16 v[72:75], v[212:215], v[224:227], 0
    v_xor_b32 v55, v215, v55
    s_nop 0
    v_cvt_pk_bf16_f32 v96, v228, v229
    v_cvt_pk_bf16_f32 v97, v230, v231
    v_mfma_f32_16x16x32_bf16 v[68:71], v[192:195], v[216:219], 0
    v_cvt_pk_bf16_f32 v98, v232, v233
    v_cvt_pk_bf16_f32 v99, v234, v235
    buffer_store_dwordx4 v[96:99], v25, s[4:7], 0 offen sc1
    s_waitcnt vmcnt(1)
    v_cmp_ne_u32 vcc, 0, v94
    s_andn2_b32 s42, s57, vcc_lo
    s_cbranch_scc1 L_c1rLs
L_c1dLs:
    buffer_load_dwordx2 v[86:87], v29, s[64:67], 0 offen sc1
    buffer_load_dwordx2 v[88:89], v30, s[64:67], 0 offen sc1
    s_waitcnt vmcnt(2)
    buffer_store_dword v1, v32, s[20:23], 0 offen offset:36 sc1
    s_waitcnt vmcnt(2)
    v_pk_add_f32 v[76:77], v[76:77], v[86:87]
    s_waitcnt vmcnt(1)
    v_pk_add_f32 v[84:85], v[84:85], v[88:89]
    v_max_f32 v104, v76, v77
    v_max_f32 v106, v84, v85
    v_mov_b32 v62, 0
    v_mov_b32 v65, 0
    v_permlane16_swap_b32 v104, v106
    v_max_f32 v104, v104, v106
    v_mov_b32 v106, v104
    s_nop 1
    v_permlane32_swap_b32 v104, v106
    v_max_f32 v104, v104, v106
    v_mul_f32 v106, s46, v104
    v_mul_f32 v104, s46, v104
    s_nop 1
    v_permlane16_swap_b32 v104, v106
    v_pk_fma_f32 v[76:77], v[76:77], s[46:47], v[104:105] op_sel:[0,0,0] op_sel_hi:[1,1,0] neg_lo:[0,0,1] neg_hi:[0,0,1]
    v_pk_fma_f32 v[84:85], v[84:85], s[46:47], v[106:107] op_sel:[0,0,0] op_sel_hi:[1,1,0] neg_lo:[0,0,1] neg_hi:[0,0,1]
    v_exp_f32 v76, v76
    v_exp_f32 v77, v77
    v_exp_f32 v84, v84
    v_exp_f32 v85, v85
    v_add_f32 v104, v76, v77
    v_add_f32 v106, v84, v85
    s_nop 1
    v_permlane16_swap_b32 v104, v106
    v_add_f32 v104, v104, v106
    v_mov_b32 v106, v104
    s_nop 1
    v_permlane32_swap_b32 v104, v106
    v_add_f32 v104, v104, v106
    v_rcp_f32 v104, v104
    s_nop 0
    v_mov_b32 v106, v104
    s_nop 1
    v_permlane16_swap_b32 v104, v106
    v_pk_mul_f32 v[76:77], v[76:77], v[104:105] op_sel:[0,0] op_sel_hi:[1,0]
    v_pk_mul_f32 v[84:85], v[84:85], v[106:107] op_sel:[0,0] op_sel_hi:[1,0]
    v_cvt_pk_bf16_f32 v76, v76, v77
    v_cvt_pk_bf16_f32 v84, v84, v85
    v_and_b32 v60, v10, v76
    v_and_b32 v61, v11, v76
    v_and_b32 v63, v12, v76
    v_and_b32 v64, v10, v84
    v_and_b32 v66, v11, v84
    v_and_b32 v67, v12, v84
    v_mfma_f32_16x16x32_bf16 v[68:71], v[56:59], v[60:63], v[68:71]
    s_nop 0
    v_mfma_f32_16x16x32_bf16 v[72:75], v[52:55], v[64:67], v[72:75]
    s_nop 5
    v_cvt_pk_bf16_f32 v100, v68, v69
    v_cvt_pk_bf16_f32 v101, v70, v71
    v_cvt_pk_bf16_f32 v102, v72, v73
    v_cvt_pk_bf16_f32 v103, v74, v75
    buffer_store_dwordx4 v[100:103], v31, s[64:67], s48 offen offset:1024 sc1
    ds_write_b128 v51, v[96:99]
    ds_write_b128 v51, v[100:103] offset:3072
    s_waitcnt lgkmcnt(0)
    s_barrier
    s_waitcnt vmcnt(0)
    buffer_store_dword v1, v32, s[20:23], 0 offen offset:72 sc1
    s_endpgm
L_c1rLs:
    s_add_u32 s40, s40, 1
    s_cmp_ge_u32 s40, 0x40000
    s_cbranch_scc1 L_c1dLs
    buffer_load_dword v94, v33, s[20:23], 0 offen sc1
    s_waitcnt vmcnt(0)
    buffer_store_dword v1, v32, s[20:23], 0 offen offset:36 sc1
    v_cmp_ne_u32 vcc, 0, v94
    s_nop 0
    s_andn2_b32 s42, s57, vcc_lo
    s_cbranch_scc1 L_c1rLs
    s_branch L_c1dLs
L_attnCs:
    s_barrier
    ds_read_b128 v[112:115], v49 offset:0
    ds_read_b128 v[116:119], v49 offset:1024
    ds_read_b128 v[120:123], v49 offset:2048
    ds_read_b128 v[128:131], v50 offset:2048
    ds_read_b128 v[124:127], v49 offset:3072
    ds_read_b128 v[132:135], v50 offset:3072
    ds_read_b128 v[196:199], v49 offset:4096
    ds_read_b128 v[200:203], v50 offset:4096
    v_mov_b32 v210, 0
    v_mov_b32 v206, 0
    v_mov_b32 v218, 0
    v_mov_b32 v222, 0
    v_mov_b32 v225, 0
    ds_read_b128 v[192:195], v49 offset:5120
    ds_read_b128 v[52:55], v50 offset:5120
    v_mov_b32 v213, 0
    v_mov_b32 v58, 0
    s_waitcnt lgkmcnt(9)
    v_and_b32 v136, v13, v112
    v_and_b32 v137, v14, v113
    s_waitcnt lgkmcnt(8)
    v_and_b32 v148, v19, v118
    v_and_b32 v149, v20, v119
    v_xor_b32 v150, v148, v118
    v_xor_b32 v151, v149, v119
    s_waitcnt lgkmcnt(6)
    v_mfma_f32_16x16x16_bf16 v[152:155], v[128:129], v[136:137], v[6:9]
    v_and_b32 v140, v15, v114
    v_and_b32 v141, v16, v115
    v_mfma_f32_16x16x16_bf16 v[156:159], v[120:121], v[136:137], v[2:5]
    v_and_b32 v144, v17, v116
    v_and_b32 v145, v18, v117
    s_waitcnt lgkmcnt(4)
    v_mfma_f32_16x16x16_bf16 v[184:187], v[134:135], v[150:151], v[6:9]
    v_xor_b32 v138, v136, v112
    v_xor_b32 v139, v137, v113
    v_mfma_f32_16x16x16_bf16 v[188:191], v[126:127], v[150:151], v[2:5]
    v_xor_b32 v142, v140, v114
    v_xor_b32 v143, v141, v115
    v_max3_f32 v76, v153, v156, v157
    v_max3_f32 v77, v155, v158, v159
    buffer_store_dwordx2 v[76:77], v27, s[4:7], 0 offen sc1
    v_xor_b32 v146, v144, v116
    v_xor_b32 v147, v145, v117
    v_mfma_f32_16x16x32_bf16 v[160:163], v[128:131], v[138:141], v[6:9]
    v_max3_f32 v84, v185, v188, v189
    v_max3_f32 v85, v187, v190, v191
    buffer_store_dwordx2 v[84:85], v28, s[4:7], 0 offen sc1
    v_mfma_f32_16x16x32_bf16 v[164:167], v[120:123], v[138:141], v[2:5]
    s_waitcnt lgkmcnt(0)
    v_and_b32 v208, v23, v198
    v_and_b32 v209, v23, v199
    v_mfma_f32_16x16x32_bf16 v[168:171], v[130:133], v[142:145], v[6:9]
    v_and_b32 v211, v23, v203
    v_and_b32 v204, v22, v196
    v_mfma_f32_16x16x32_bf16 v[172:175], v[122:125], v[142:145], v[2:5]
    v_and_b32 v205, v22, v197
    v_and_b32 v207, v22, v201
    v_mfma_f32_16x16x32_bf16 v[176:179], v[132:135], v[146:149], v[6:9]
    v_max3_f32 v78, v161, v164, v165
    v_max3_f32 v79, v163, v166, v167
    v_mfma_f32_16x16x32_bf16 v[180:183], v[124:127], v[146:149], v[2:5]
    v_max_f32 v104, v78, v79
    v_xor_b32 v202, v209, v199
    v_max3_f32 v80, v169, v172, v173
    v_max3_f32 v81, v171, v174, v175
    v_max_f32 v106, v80, v81
    v_xor_b32 v200, v208, v198
    v_xor_b32 v203, v211, v203
    v_permlane16_swap_b32 v104, v106
    v_max3_f32 v82, v177, v180, v181
    v_max3_f32 v83, v179, v182, v183
    v_max_f32 v108, v82, v83
    v_max_f32 v110, v82, v83
    v_max_f32 v104, v104, v106
    v_xor_b32 v196, v204, v196
    v_permlane16_swap_b32 v108, v110
    v_max_f32 v108, v108, v110
    v_xor_b32 v197, v205, v197
    v_xor_b32 v199, v207, v201
    v_permlane32_swap_b32 v104, v108
    v_max_f32 v104, v104, v108
    v_mul_f32 v108, s46, v104
    v_mul_f32 v104, s46, v104
    v_and_b32 v214, v24, v195
    v_xor_b32 v54, v214, v195
    v_permlane32_swap_b32 v104, v108
    v_mov_b32 v106, v104
    v_pk_fma_f32 v[82:83], v[82:83], s[46:47], v[108:109] op_sel:[0,0,0] op_sel_hi:[1,1,0] neg_lo:[0,0,1] neg_hi:[0,0,1]
    v_exp_f32 v82, v82
    v_permlane16_swap_b32 v104, v106
    v_pk_fma_f32 v[78:79], v[78:79], s[46:47], v[104:105] op_sel:[0,0,0] op_sel_hi:[1,1,0] neg_lo:[0,0,1] neg_hi:[0,0,1]
    v_pk_fma_f32 v[80:81], v[80:81], s[46:47], v[106:107] op_sel:[0,0,0] op_sel_hi:[1,1,0] neg_lo:[0,0,1] neg_hi:[0,0,1]
    v_exp_f32 v78, v78
    v_exp_f32 v79, v79
    v_exp_f32 v80, v80
    v_exp_f32 v81, v81
    v_exp_f32 v83, v83
    v_add_f32 v104, v78, v79
    v_add_f32 v106, v80, v81
    v_add_f32 v108, v82, v83
    v_add_f32 v110, v82, v83
    v_permlane16_swap_b32 v104, v106
    v_add_f32 v104, v104, v106
    v_permlane16_swap_b32 v108, v110
    v_add_f32 v108, v108, v110
    v_and_b32 v56, v21, v192
    s_waitcnt vmcnt(0)
    buffer_store_dword v1, v32, s[20:23], 0 offen offset:0 sc1
    v_permlane32_swap_b32 v104, v108
    v_add_f32 v104, v104, v108
    v_rcp_f32 v108, v104
    v_rcp_f32 v104, v104
    v_and_b32 v57, v21, v193
    v_and_b32 v59, v21, v53
    v_permlane32_swap_b32 v104, v108
    v_mov_b32 v106, v104
    v_pk_mul_f32 v[82:83], v[82:83], v[108:109] op_sel:[0,0] op_sel_hi:[1,0]
    v_cvt_pk_bf16_f32 v82, v82, v83
    v_permlane16_swap_b32 v104, v106
    v_pk_mul_f32 v[78:79], v[78:79], v[104:105] op_sel:[0,0] op_sel_hi:[1,0]
    v_pk_mul_f32 v[80:81], v[80:81], v[106:107] op_sel:[0,0] op_sel_hi:[1,0]
    v_cvt_pk_bf16_f32 v78, v78, v79
    v_cvt_pk_bf16_f32 v80, v80, v81
    v_and_b32 v216, v10, v78
    v_and_b32 v217, v11, v78
    v_and_b32 v219, v12, v78
    v_and_b32 v220, v10, v80
    v_and_b32 v221, v11, v80
    v_and_b32 v223, v12, v80
    v_mfma_f32_16x16x32_bf16 v[228:231], v[204:207], v[216:219], 0
    v_and_b32 v224, v10, v82
    v_and_b32 v226, v11, v82
    v_mfma_f32_16x16x32_bf16 v[232:235], v[208:211], v[220:223], 0
    v_and_b32 v227, v12, v82
    v_and_b32 v212, v24, v194
    v_mfma_f32_16x16x32_bf16 v[228:231], v[196:199], v[220:223], v[228:231]
    v_and_b32 v215, v24, v55
    v_xor_b32 v192, v56, v192
    v_mfma_f32_16x16x32_bf16 v[232:235], v[200:203], v[224:227], v[232:235]
    v_xor_b32 v193, v57, v193
    v_xor_b32 v195, v59, v53
    v_mfma_f32_16x16x32_bf16 v[72:75], v[212:215], v[224:227], 0
    v_xor_b32 v52, v212, v194
    v_xor_b32 v55, v215, v55
    v_cvt_pk_bf16_f32 v96, v228, v229
    v_cvt_pk_bf16_f32 v97, v230, v231
    v_mfma_f32_16x16x32_bf16 v[68:71], v[192:195], v[216:219], 0
    v_cvt_pk_bf16_f32 v98, v232, v233
    v_cvt_pk_bf16_f32 v99, v234, v235
    buffer_store_dwordx4 v[96:99], v25, s[4:7], 0 offen sc1
    buffer_load_dword v94, v33, s[20:23], 0 offen sc1
    s_waitcnt vmcnt(0)
    v_cmp_ne_u32 vcc, 0, v94
    s_andn2_b32 s42, s57, vcc_lo
    s_cbranch_scc1 L_c1rCs
L_c1dCs:
    buffer_load_dwordx2 v[86:87], v29, s[4:7], 0 offen sc1
    buffer_load_dwordx2 v[88:89], v30, s[4:7], 0 offen sc1
    buffer_store_dword v1, v32, s[20:23], 0 offen offset:36 sc1
    s_waitcnt vmcnt(2)
    v_pk_add_f32 v[76:77], v[76:77], v[86:87]
    s_waitcnt vmcnt(1)
    v_pk_add_f32 v[84:85], v[84:85], v[88:89]
    v_max_f32 v104, v76, v77
    v_max_f32 v106, v84, v85
    v_mov_b32 v62, 0
    v_mov_b32 v65, 0
    v_permlane16_swap_b32 v104, v106
    v_max_f32 v104, v104, v106
    v_mov_b32 v106, v104
    ds_read_b32 v95, v45 offset:4
    s_nop 0
    v_permlane32_swap_b32 v104, v106
    v_max_f32 v104, v104, v106
    v_mul_f32 v106, s46, v104
    v_mul_f32 v104, s46, v104
    s_nop 1
    v_permlane16_swap_b32 v104, v106
    v_pk_fma_f32 v[76:77], v[76:77], s[46:47], v[104:105] op_sel:[0,0,0] op_sel_hi:[1,1,0] neg_lo:[0,0,1] neg_hi:[0,0,1]
    v_pk_fma_f32 v[84:85], v[84:85], s[46:47], v[106:107] op_sel:[0,0,0] op_sel_hi:[1,1,0] neg_lo:[0,0,1] neg_hi:[0,0,1]
    v_exp_f32 v76, v76
    v_exp_f32 v77, v77
    v_exp_f32 v84, v84
    v_exp_f32 v85, v85
    v_add_f32 v104, v76, v77
    v_add_f32 v106, v84, v85
    s_nop 1
    v_permlane16_swap_b32 v104, v106
    v_add_f32 v104, v104, v106
    v_mov_b32 v106, v104
    s_nop 1
    v_permlane32_swap_b32 v104, v106
    v_add_f32 v104, v104, v106
    v_rcp_f32 v106, v104
    v_rcp_f32 v104, v104
    s_nop 1
    v_permlane16_swap_b32 v104, v106
    v_pk_mul_f32 v[76:77], v[76:77], v[104:105] op_sel:[0,0] op_sel_hi:[1,0]
    v_pk_mul_f32 v[84:85], v[84:85], v[106:107] op_sel:[0,0] op_sel_hi:[1,0]
    v_cvt_pk_bf16_f32 v76, v76, v77
    v_cvt_pk_bf16_f32 v84, v84, v85
    v_and_b32 v60, v10, v76
    v_and_b32 v61, v11, v76
    v_and_b32 v63, v12, v76
    v_and_b32 v64, v10, v84
    v_and_b32 v66, v11, v84
    v_and_b32 v67, v12, v84
    v_mfma_f32_16x16x32_bf16 v[68:71], v[56:59], v[60:63], v[68:71]
    s_nop 0
    v_mfma_f32_16x16x32_bf16 v[72:75], v[52:55], v[64:67], v[72:75]
    s_nop 5
    v_cvt_pk_bf16_f32 v100, v68, v69
    v_cvt_pk_bf16_f32 v101, v70, v71
    v_cvt_pk_bf16_f32 v102, v72, v73
    v_cvt_pk_bf16_f32 v103, v74, v75
    buffer_store_dwordx4 v[100:103], v26, s[4:7], 0 offen sc1
    s_waitcnt lgkmcnt(0)
    v_cmp_gt_u32 vcc, 2, v95
    s_cbranch_vccnz L_worCs
L_wodCs:
    ds_write_b128 v51, v[96:99]
    ds_write_b128 v51, v[100:103] offset:3072
    ds_read_b64_tr_b16 v[112:113], v34 offset:2048
    ds_read_b64_tr_b16 v[114:115], v34 offset:4096
    ds_read_b64_tr_b16 v[116:117], v35 offset:2048
    ds_read_b64_tr_b16 v[118:119], v35 offset:4096
    ds_read_b64_tr_b16 v[184:185], v34 offset:0
    ds_read_b64_tr_b16 v[186:187], v34 offset:6144
    ds_read_b64_tr_b16 v[188:189], v35 offset:0
    ds_read_b64_tr_b16 v[190:191], v35 offset:6144
    ds_read_b64_tr_b16 v[120:121], v34 offset:10240
    ds_read_b64_tr_b16 v[122:123], v34 offset:12288
    ds_read_b64_tr_b16 v[124:125], v35 offset:10240
    ds_read_b64_tr_b16 v[126:127], v35 offset:12288
    ds_read_b64_tr_b16 v[128:129], v34 offset:18432
    ds_read_b64_tr_b16 v[130:131], v34 offset:20480
    ds_read_b64_tr_b16 v[132:133], v35 offset:18432
    ds_read_b64_tr_b16 v[134:135], v35 offset:20480
    ds_read_b64_tr_b16 v[136:137], v34 offset:26624
    ds_read_b64_tr_b16 v[138:139], v34 offset:28672
    ds_read_b64_tr_b16 v[140:141], v35 offset:26624
    ds_read_b64_tr_b16 v[142:143], v35 offset:28672
    ds_read_b64_tr_b16 v[144:145], v36 offset:2048
    ds_read_b64_tr_b16 v[146:147], v36 offset:4096
    ds_read_b64_tr_b16 v[148:149], v37 offset:2048
    ds_read_b64_tr_b16 v[150:151], v37 offset:4096
    s_waitcnt vmcnt(0)
    buffer_store_dword v1, v32, s[20:23], 0 offen offset:72 sc1
    ds_read_b64_tr_b16 v[152:153], v36 offset:10240
    ds_read_b64_tr_b16 v[154:155], v36 offset:12288
    ds_read_b64_tr_b16 v[156:157], v37 offset:10240
    ds_read_b64_tr_b16 v[158:159], v37 offset:12288
    ds_read_b64_tr_b16 v[160:161], v36 offset:18432
    ds_read_b64_tr_b16 v[162:163], v36 offset:20480
    ds_read_b64_tr_b16 v[164:165], v37 offset:18432
    ds_read_b64_tr_b16 v[166:167], v37 offset:20480
    ds_read_b64_tr_b16 v[168:169], v36 offset:26624
    ds_read_b64_tr_b16 v[170:171], v36 offset:28672
    ds_read_b64_tr_b16 v[172:173], v37 offset:26624
    ds_read_b64_tr_b16 v[174:175], v37 offset:28672
    ds_read_b64_tr_b16 v[176:177], v36 offset:34816
    ds_read_b64_tr_b16 v[178:179], v36 offset:36864
    ds_read_b64_tr_b16 v[180:181], v37 offset:34816
    ds_read_b64_tr_b16 v[182:183], v37 offset:36864
    v_mov_b32 v45, s41
    s_waitcnt lgkmcnt(0)
    s_barrier
    ds_read_b128 v[76:79], v43 offset:0
    ds_read_b128 v[80:83], v43 offset:1024
    ds_read_b128 v[84:87], v43 offset:2048
    ds_read_b128 v[88:91], v43 offset:3072
    ds_read_b128 v[92:95], v43 offset:4096
    ds_read_b128 v[96:99], v43 offset:5120
    s_waitcnt lgkmcnt(5)
    v_mfma_f32_16x16x32_bf16 v[52:55], v[112:115], v[76:79], 0
    ds_read_b32 v108, v45 offset:68
    ds_read_b64_tr_b16 v[192:193], v34 offset:8192
    v_mfma_f32_16x16x32_bf16 v[56:59], v[116:119], v[76:79], 0
    ds_read_b64_tr_b16 v[194:195], v34 offset:14336
    s_waitcnt lgkmcnt(7)
    v_mfma_f32_16x16x32_bf16 v[60:63], v[112:115], v[80:83], 0
    ds_read_b64_tr_b16 v[196:197], v35 offset:8192
    ds_read_b64_tr_b16 v[198:199], v35 offset:14336
    v_mfma_f32_16x16x32_bf16 v[64:67], v[116:119], v[80:83], 0
    ds_read_b64_tr_b16 v[200:201], v34 offset:16384
    s_waitcnt lgkmcnt(9)
    v_mfma_f32_16x16x32_bf16 v[68:71], v[112:115], v[84:87], 0
    s_waitcnt lgkmcnt(5)
    v_cmp_eq_u32 vcc, 0, v108
    ds_read_b64_tr_b16 v[202:203], v34 offset:22528
    v_mfma_f32_16x16x32_bf16 v[72:75], v[116:119], v[84:87], 0
    ds_read_b64_tr_b16 v[204:205], v35 offset:16384
    v_mfma_f32_16x16x32_bf16 v[52:55], v[184:187], v[88:91], v[52:55]
    s_cbranch_vccnz L_m1rCs
L_m1dCs:
    ds_read_b128 v[100:103], v43 offset:6144
    v_mfma_f32_16x16x32_bf16 v[56:59], v[188:191], v[88:91], v[56:59]
    ds_read_b128 v[104:107], v43 offset:7168
    v_mfma_f32_16x16x32_bf16 v[60:63], v[184:187], v[92:95], v[60:63]
    ds_read_b32 v108, v45 offset:72
    ds_read_b128 v[76:79], v43 offset:8192
    v_mfma_f32_16x16x32_bf16 v[64:67], v[188:191], v[92:95], v[64:67]
    ds_read_b128 v[80:83], v43 offset:9216
    v_mfma_f32_16x16x32_bf16 v[68:71], v[184:187], v[96:99], v[68:71]
    ds_read_b64_tr_b16 v[206:207], v35 offset:22528
    ds_read_b64_tr_b16 v[208:209], v34 offset:24576
    v_mfma_f32_16x16x32_bf16 v[72:75], v[188:191], v[96:99], v[72:75]
    ds_read_b64_tr_b16 v[210:211], v34 offset:30720
    s_waitcnt lgkmcnt(7)
    v_mfma_f32_16x16x32_bf16 v[52:55], v[120:123], v[100:103], v[52:55]
    s_waitcnt lgkmcnt(5)
    v_cmp_eq_u32 vcc, 0, v108
    ds_read_b64_tr_b16 v[212:213], v35 offset:24576
    v_mfma_f32_16x16x32_bf16 v[56:59], v[124:127], v[100:103], v[56:59]
    ds_read_b64_tr_b16 v[214:215], v35 offset:30720
    v_mfma_f32_16x16x32_bf16 v[60:63], v[120:123], v[104:107], v[60:63]
    s_cbranch_vccnz L_m2rCs
L_m2dCs:
    ds_read_b128 v[84:87], v43 offset:10240
    v_mfma_f32_16x16x32_bf16 v[64:67], v[124:127], v[104:107], v[64:67]
    ds_read_b128 v[88:91], v43 offset:11264
    s_waitcnt lgkmcnt(8)
    v_mfma_f32_16x16x32_bf16 v[52:55], v[128:131], v[76:79], v[52:55]
    ds_read_b32 v108, v45 offset:76
    ds_read_b128 v[92:95], v43 offset:12288
    v_mfma_f32_16x16x32_bf16 v[56:59], v[132:135], v[76:79], v[56:59]
    ds_read_b128 v[96:99], v43 offset:13312
    s_waitcnt lgkmcnt(10)
    v_mfma_f32_16x16x32_bf16 v[60:63], v[128:131], v[80:83], v[60:63]
    ds_read_b64_tr_b16 v[216:217], v36 offset:0
    ds_read_b64_tr_b16 v[218:219], v36 offset:6144
    v_mfma_f32_16x16x32_bf16 v[64:67], v[132:135], v[80:83], v[64:67]
    ds_read_b64_tr_b16 v[220:221], v37 offset:0
    s_waitcnt lgkmcnt(7)
    v_mfma_f32_16x16x32_bf16 v[52:55], v[136:139], v[84:87], v[52:55]
    s_waitcnt lgkmcnt(5)
    v_cmp_eq_u32 vcc, 0, v108
    ds_read_b64_tr_b16 v[222:223], v37 offset:6144
    v_mfma_f32_16x16x32_bf16 v[56:59], v[140:143], v[84:87], v[56:59]
    ds_read_b64_tr_b16 v[224:225], v36 offset:8192
    v_mfma_f32_16x16x32_bf16 v[60:63], v[136:139], v[88:91], v[60:63]
    s_cbranch_vccnz L_m3rCs
L_m3dCs:
    ds_read_b128 v[100:103], v43 offset:14336
    v_mfma_f32_16x16x32_bf16 v[64:67], v[140:143], v[88:91], v[64:67]
    ds_read_b128 v[104:107], v43 offset:15360
    s_waitcnt lgkmcnt(8)
    v_mfma_f32_16x16x32_bf16 v[52:55], v[144:147], v[92:95], v[52:55]
    ds_read_b32 v108, v45 offset:80
    ds_read_b128 v[76:79], v43 offset:16384
    v_mfma_f32_16x16x32_bf16 v[56:59], v[148:151], v[92:95], v[56:59]
    ds_read_b128 v[80:83], v43 offset:17408
    s_waitcnt lgkmcnt(10)
    v_mfma_f32_16x16x32_bf16 v[60:63], v[144:147], v[96:99], v[60:63]
    ds_read_b64_tr_b16 v[226:227], v36 offset:14336
    ds_read_b64_tr_b16 v[228:229], v37 offset:8192
    v_mfma_f32_16x16x32_bf16 v[64:67], v[148:151], v[96:99], v[64:67]
    ds_read_b64_tr_b16 v[230:231], v37 offset:14336
    s_waitcnt lgkmcnt(7)
    v_mfma_f32_16x16x32_bf16 v[52:55], v[152:155], v[100:103], v[52:55]
    s_waitcnt lgkmcnt(5)
    v_cmp_eq_u32 vcc, 0, v108
    ds_read_b64_tr_b16 v[232:233], v36 offset:16384
    v_mfma_f32_16x16x32_bf16 v[56:59], v[156:159], v[100:103], v[56:59]
    ds_read_b64_tr_b16 v[234:235], v36 offset:22528
    v_mfma_f32_16x16x32_bf16 v[60:63], v[152:155], v[104:107], v[60:63]
    s_cbranch_vccnz L_m4rCs
L_m4dCs:
    ds_read_b128 v[84:87], v47 offset:0
    v_mfma_f32_16x16x32_bf16 v[64:67], v[156:159], v[104:107], v[64:67]
    ds_read_b128 v[88:91], v47 offset:2048
    s_waitcnt lgkmcnt(8)
    v_mfma_f32_16x16x32_bf16 v[52:55], v[160:163], v[76:79], v[52:55]
    ds_read_b32 v108, v45 offset:84
    ds_read_b128 v[92:95], v47 offset:4096
    v_mfma_f32_16x16x32_bf16 v[56:59], v[164:167], v[76:79], v[56:59]
    ds_read_b128 v[96:99], v47 offset:6144
    s_waitcnt lgkmcnt(10)
    v_mfma_f32_16x16x32_bf16 v[60:63], v[160:163], v[80:83], v[60:63]
    ds_read_b64_tr_b16 v[236:237], v37 offset:16384
    ds_read_b64_tr_b16 v[238:239], v37 offset:22528
    v_mfma_f32_16x16x32_bf16 v[64:67], v[164:167], v[80:83], v[64:67]
    ds_read_b64_tr_b16 v[240:241], v36 offset:24576
    s_waitcnt lgkmcnt(7)
    v_mfma_f32_16x16x32_bf16 v[52:55], v[168:171], v[84:87], v[52:55]
    s_waitcnt lgkmcnt(5)
    v_cmp_eq_u32 vcc, 0, v108
    ds_read_b64_tr_b16 v[242:243], v36 offset:30720
    v_mfma_f32_16x16x32_bf16 v[56:59], v[172:175], v[84:87], v[56:59]
    ds_read_b64_tr_b16 v[244:245], v37 offset:24576
    v_mfma_f32_16x16x32_bf16 v[60:63], v[168:171], v[88:91], v[60:63]
    s_cbranch_vccnz L_m5rCs
L_m5dCs:
    ds_read_b128 v[100:103], v47 offset:8192
    v_mfma_f32_16x16x32_bf16 v[64:67], v[172:175], v[88:91], v[64:67]
    ds_read_b128 v[104:107], v47 offset:10240
    s_waitcnt lgkmcnt(8)
    v_mfma_f32_16x16x32_bf16 v[52:55], v[176:179], v[92:95], v[52:55]
    ds_read_b32 v108, v45 offset:88
    ds_read_b128 v[76:79], v47 offset:12288
    v_mfma_f32_16x16x32_bf16 v[56:59], v[180:183], v[92:95], v[56:59]
    ds_read_b128 v[80:83], v44 offset:0
    s_waitcnt lgkmcnt(10)
    v_mfma_f32_16x16x32_bf16 v[60:63], v[176:179], v[96:99], v[60:63]
    ds_read_b64_tr_b16 v[246:247], v37 offset:30720
    ds_read_b64_tr_b16 v[248:249], v36 offset:32768
    v_mfma_f32_16x16x32_bf16 v[64:67], v[180:183], v[96:99], v[64:67]
    ds_read_b64_tr_b16 v[250:251], v36 offset:38912
    s_waitcnt lgkmcnt(7)
    v_mfma_f32_16x16x32_bf16 v[68:71], v[120:123], v[100:103], v[68:71]
    s_waitcnt lgkmcnt(5)
    v_cmp_eq_u32 vcc, 0, v108
    ds_read_b64_tr_b16 v[252:253], v37 offset:32768
    v_mfma_f32_16x16x32_bf16 v[72:75], v[124:127], v[100:103], v[72:75]
    ds_read_b64_tr_b16 v[254:255], v37 offset:38912
    v_mfma_f32_16x16x32_bf16 v[68:71], v[128:131], v[104:107], v[68:71]
    s_cbranch_vccnz L_m6rCs
L_m6dCs:
    ds_read_b128 v[84:87], v44 offset:2048
    v_mfma_f32_16x16x32_bf16 v[72:75], v[132:135], v[104:107], v[72:75]
    ds_read_b128 v[88:91], v44 offset:4096
    s_waitcnt lgkmcnt(8)
    v_mfma_f32_16x16x32_bf16 v[68:71], v[136:139], v[76:79], v[68:71]
    ds_read_b32 v108, v45 offset:92
    ds_read_b128 v[92:95], v44 offset:6144
    v_mfma_f32_16x16x32_bf16 v[72:75], v[140:143], v[76:79], v[72:75]
    ds_read_b128 v[96:99], v44 offset:8192
    s_waitcnt lgkmcnt(10)
    v_mfma_f32_16x16x32_bf16 v[68:71], v[144:147], v[80:83], v[68:71]
    v_mfma_f32_16x16x32_bf16 v[72:75], v[148:151], v[80:83], v[72:75]
    s_waitcnt lgkmcnt(4)
    v_mfma_f32_16x16x32_bf16 v[68:71], v[152:155], v[84:87], v[68:71]
    s_waitcnt lgkmcnt(2)
    v_cmp_eq_u32 vcc, 0, v108
    v_mfma_f32_16x16x32_bf16 v[72:75], v[156:159], v[84:87], v[72:75]
    v_mfma_f32_16x16x32_bf16 v[68:71], v[160:163], v[88:91], v[68:71]
    s_cbranch_vccnz L_m7rCs
L_m7dCs:
    ds_read_b128 v[100:103], v44 offset:10240
    v_mfma_f32_16x16x32_bf16 v[72:75], v[164:167], v[88:91], v[72:75]
    ds_read_b128 v[104:107], v44 offset:12288
    s_waitcnt lgkmcnt(3)
    v_mfma_f32_16x16x32_bf16 v[68:71], v[168:171], v[92:95], v[68:71]
    ds_read_b32 v108, v45 offset:96
    ds_read_b128 v[76:79], v44 offset:14336
    v_mfma_f32_16x16x32_bf16 v[72:75], v[172:175], v[92:95], v[72:75]
    ds_read_b128 v[80:83], v44 offset:16384
    s_waitcnt lgkmcnt(5)
    v_mfma_f32_16x16x32_bf16 v[68:71], v[176:179], v[96:99], v[68:71]
    v_mfma_f32_16x16x32_bf16 v[72:75], v[180:183], v[96:99], v[72:75]
    s_waitcnt lgkmcnt(4)
    v_mfma_f32_16x16x32_bf16 v[52:55], v[192:195], v[100:103], v[52:55]
    s_waitcnt lgkmcnt(2)
    v_cmp_eq_u32 vcc, 0, v108
    v_mfma_f32_16x16x32_bf16 v[56:59], v[196:199], v[100:103], v[56:59]
    v_mfma_f32_16x16x32_bf16 v[60:63], v[192:195], v[104:107], v[60:63]
    s_cbranch_vccnz L_m8rCs
L_m8dCs:
    ds_read_b128 v[84:87], v44 offset:18432
    v_mfma_f32_16x16x32_bf16 v[64:67], v[196:199], v[104:107], v[64:67]
    ds_read_b128 v[88:91], v44 offset:20480
    s_waitcnt lgkmcnt(3)
    v_mfma_f32_16x16x32_bf16 v[52:55], v[200:203], v[76:79], v[52:55]
    ds_read_b32 v108, v45 offset:100
    ds_read_b128 v[92:95], v44 offset:22528
    v_mfma_f32_16x16x32_bf16 v[56:59], v[204:207], v[76:79], v[56:59]
    ds_read_b128 v[96:99], v44 offset:24576
    s_waitcnt lgkmcnt(5)
    v_mfma_f32_16x16x32_bf16 v[60:63], v[200:203], v[80:83], v[60:63]
    v_mfma_f32_16x16x32_bf16 v[64:67], v[204:207], v[80:83], v[64:67]
    s_waitcnt lgkmcnt(4)
    v_mfma_f32_16x16x32_bf16 v[52:55], v[208:211], v[84:87], v[52:55]
    s_waitcnt lgkmcnt(2)
    v_cmp_eq_u32 vcc, 0, v108
    v_mfma_f32_16x16x32_bf16 v[56:59], v[212:215], v[84:87], v[56:59]
    v_mfma_f32_16x16x32_bf16 v[60:63], v[208:211], v[88:91], v[60:63]
    s_cbranch_vccnz L_m9rCs
L_m9dCs:
    ds_read_b128 v[100:103], v44 offset:26624
    v_mfma_f32_16x16x32_bf16 v[64:67], v[212:215], v[88:91], v[64:67]
    ds_read_b128 v[104:107], v44 offset:28672
    s_waitcnt lgkmcnt(3)
    v_mfma_f32_16x16x32_bf16 v[52:55], v[216:219], v[92:95], v[52:55]
    ds_read_b32 v108, v45 offset:104
    ds_read_b128 v[76:79], v44 offset:30720
    v_mfma_f32_16x16x32_bf16 v[56:59], v[220:223], v[92:95], v[56:59]
    ds_read_b128 v[80:83], v44 offset:32768
    s_waitcnt lgkmcnt(5)
    v_mfma_f32_16x16x32_bf16 v[60:63], v[216:219], v[96:99], v[60:63]
    v_mfma_f32_16x16x32_bf16 v[64:67], v[220:223], v[96:99], v[64:67]
    s_waitcnt lgkmcnt(4)
    v_mfma_f32_16x16x32_bf16 v[52:55], v[224:227], v[100:103], v[52:55]
    s_waitcnt lgkmcnt(2)
    v_cmp_eq_u32 vcc, 0, v108
    v_mfma_f32_16x16x32_bf16 v[56:59], v[228:231], v[100:103], v[56:59]
    v_mfma_f32_16x16x32_bf16 v[60:63], v[224:227], v[104:107], v[60:63]
    s_cbranch_vccnz L_m10rCs
L_m10dCs:
    ds_read_b128 v[84:87], v44 offset:34816
    v_mfma_f32_16x16x32_bf16 v[64:67], v[228:231], v[104:107], v[64:67]
    ds_read_b128 v[88:91], v47 offset:15360
    s_waitcnt lgkmcnt(3)
    v_mfma_f32_16x16x32_bf16 v[52:55], v[232:235], v[76:79], v[52:55]
    ds_read_b32 v108, v45 offset:108
    ds_read_b128 v[92:95], v47 offset:17408
    v_mfma_f32_16x16x32_bf16 v[56:59], v[236:239], v[76:79], v[56:59]
    ds_read_b128 v[96:99], v47 offset:19456
    s_waitcnt lgkmcnt(5)
    v_mfma_f32_16x16x32_bf16 v[60:63], v[232:235], v[80:83], v[60:63]
    v_mfma_f32_16x16x32_bf16 v[64:67], v[236:239], v[80:83], v[64:67]
    s_waitcnt lgkmcnt(4)
    v_mfma_f32_16x16x32_bf16 v[52:55], v[240:243], v[84:87], v[52:55]
    s_waitcnt lgkmcnt(2)
    v_cmp_eq_u32 vcc, 0, v108
    v_mfma_f32_16x16x32_bf16 v[56:59], v[244:247], v[84:87], v[56:59]
    v_mfma_f32_16x16x32_bf16 v[60:63], v[240:243], v[88:91], v[60:63]
    s_cbranch_vccnz L_m11rCs
L_m11dCs:
    ds_read_b128 v[100:103], v47 offset:21504
    v_mfma_f32_16x16x32_bf16 v[64:67], v[244:247], v[88:91], v[64:67]
    ds_read_b128 v[104:107], v47 offset:25600
    s_waitcnt lgkmcnt(3)
    v_mfma_f32_16x16x32_bf16 v[52:55], v[248:251], v[92:95], v[52:55]
    ds_read_b32 v108, v45 offset:112
    ds_read_b128 v[76:79], v47 offset:27648
    v_mfma_f32_16x16x32_bf16 v[56:59], v[252:255], v[92:95], v[56:59]
    ds_read_b128 v[80:83], v47 offset:33792
    s_waitcnt lgkmcnt(5)
    v_mfma_f32_16x16x32_bf16 v[60:63], v[248:251], v[96:99], v[60:63]
    v_mfma_f32_16x16x32_bf16 v[64:67], v[252:255], v[96:99], v[64:67]
    s_waitcnt lgkmcnt(4)
    v_mfma_f32_16x16x32_bf16 v[68:71], v[192:195], v[100:103], v[68:71]
    s_waitcnt lgkmcnt(2)
    v_cmp_eq_u32 vcc, 0, v108
    v_mfma_f32_16x16x32_bf16 v[72:75], v[196:199], v[100:103], v[72:75]
    v_mfma_f32_16x16x32_bf16 v[68:71], v[200:203], v[104:107], v[68:71]
    s_cbranch_vccnz L_m12rCs
L_m12dCs:
    ds_read_b128 v[84:87], v47 offset:35840
    v_mfma_f32_16x16x32_bf16 v[72:75], v[204:207], v[104:107], v[72:75]
    ds_read_b128 v[88:91], v47 offset:41984
    s_waitcnt lgkmcnt(3)
    v_mfma_f32_16x16x32_bf16 v[68:71], v[208:211], v[76:79], v[68:71]
    ds_read_b128 v[92:95], v47 offset:44032
    ds_read_b128 v[96:99], v47 offset:50176
    v_mfma_f32_16x16x32_bf16 v[72:75], v[212:215], v[76:79], v[72:75]
    v_cvt_pk_bf16_f32 v52, v52, v53
    s_waitcnt lgkmcnt(4)
    v_mfma_f32_16x16x32_bf16 v[68:71], v[216:219], v[80:83], v[68:71]
    v_cvt_pk_bf16_f32 v53, v54, v55
    v_cvt_pk_bf16_f32 v56, v56, v57
    v_mfma_f32_16x16x32_bf16 v[72:75], v[220:223], v[80:83], v[72:75]
    v_cvt_pk_bf16_f32 v57, v58, v59
    s_waitcnt lgkmcnt(3)
    v_mfma_f32_16x16x32_bf16 v[68:71], v[224:227], v[84:87], v[68:71]
    ds_write_b64 v38, v[52:53] offset:0
    v_mfma_f32_16x16x32_bf16 v[72:75], v[228:231], v[84:87], v[72:75]
    ds_write_b64 v48, v[56:57] offset:0
    s_waitcnt lgkmcnt(4)
    v_mfma_f32_16x16x32_bf16 v[68:71], v[232:235], v[88:91], v[68:71]
    ds_read_b128 v[112:115], v39 offset:0
    v_cvt_pk_bf16_f32 v60, v60, v61
    v_mfma_f32_16x16x32_bf16 v[72:75], v[236:239], v[88:91], v[72:75]
    v_cvt_pk_bf16_f32 v61, v62, v63
    s_waitcnt lgkmcnt(4)
    v_mfma_f32_16x16x32_bf16 v[68:71], v[240:243], v[92:95], v[68:71]
    v_cvt_pk_bf16_f32 v64, v64, v65
    v_cvt_pk_bf16_f32 v65, v66, v67
    v_mfma_f32_16x16x32_bf16 v[72:75], v[244:247], v[92:95], v[72:75]
    ds_write_b64 v38, v[60:61] offset:0
    s_waitcnt lgkmcnt(4)
    v_mfma_f32_16x16x32_bf16 v[68:71], v[248:251], v[96:99], v[68:71]
    ds_write_b64 v48, v[64:65] offset:0
    v_mfma_f32_16x16x32_bf16 v[72:75], v[252:255], v[96:99], v[72:75]
    ds_read_b128 v[116:119], v39 offset:0
    s_nop 4
    v_cvt_pk_bf16_f32 v68, v68, v69
    v_cvt_pk_bf16_f32 v69, v70, v71
    v_cvt_pk_bf16_f32 v72, v72, v73
    v_cvt_pk_bf16_f32 v73, v74, v75
    s_waitcnt lgkmcnt(3)
    buffer_store_dwordx4 v[112:115], v40, s[16:19], 0 offen nt
    ds_write_b64 v38, v[68:69] offset:0
    ds_write_b64 v48, v[72:73] offset:0
    ds_read_b128 v[120:123], v39 offset:0
    s_waitcnt lgkmcnt(3)
    buffer_store_dwordx4 v[116:119], v41, s[16:19], 0 offen nt
    s_waitcnt lgkmcnt(0)
    buffer_store_dwordx4 v[120:123], v42, s[16:19], 0 offen nt
    s_endpgm
L_c1rCs:
    s_add_u32 s40, s40, 1
    s_cmp_ge_u32 s40, 0x40000
    s_cbranch_scc1 L_c1dCs
    buffer_load_dword v94, v33, s[20:23], 0 offen sc1
    s_waitcnt vmcnt(0)
    buffer_store_dword v1, v32, s[20:23], 0 offen offset:36 sc1
    v_cmp_ne_u32 vcc, 0, v94
    s_nop 0
    s_andn2_b32 s42, s57, vcc_lo
    s_cbranch_scc1 L_c1rCs
    s_branch L_c1dCs
L_worCs:
    s_add_u32 s40, s40, 1
    s_cmp_ge_u32 s40, 0x40000
    s_cbranch_scc1 L_wodCs
    ds_read_b32 v95, v45 offset:4
    s_waitcnt lgkmcnt(0)
    v_cmp_gt_u32 vcc, 2, v95
    s_cbranch_vccnz L_worCs
    s_branch L_wodCs
L_m1rCs:
    ds_read_b32 v108, v45 offset:68
    s_add_u32 s40, s40, 1
    s_cmp_ge_u32 s40, 0x40000
    s_cbranch_scc1 L_m1dCs
    s_waitcnt lgkmcnt(0)
    v_cmp_eq_u32 vcc, 0, v108
    s_cbranch_vccnz L_m1rCs
    s_branch L_m1dCs
L_m2rCs:
    ds_read_b32 v108, v45 offset:72
    s_add_u32 s40, s40, 1
    s_cmp_ge_u32 s40, 0x40000
    s_cbranch_scc1 L_m2dCs
    s_waitcnt lgkmcnt(0)
    v_cmp_eq_u32 vcc, 0, v108
    s_cbranch_vccnz L_m2rCs
    s_branch L_m2dCs
L_m3rCs:
    ds_read_b32 v108, v45 offset:76
    s_add_u32 s40, s40, 1
    s_cmp_ge_u32 s40, 0x40000
    s_cbranch_scc1 L_m3dCs
    s_waitcnt lgkmcnt(0)
    v_cmp_eq_u32 vcc, 0, v108
    s_cbranch_vccnz L_m3rCs
    s_branch L_m3dCs
L_m4rCs:
    ds_read_b32 v108, v45 offset:80
    s_add_u32 s40, s40, 1
    s_cmp_ge_u32 s40, 0x40000
    s_cbranch_scc1 L_m4dCs
    s_waitcnt lgkmcnt(0)
    v_cmp_eq_u32 vcc, 0, v108
    s_cbranch_vccnz L_m4rCs
    s_branch L_m4dCs
L_m5rCs:
    ds_read_b32 v108, v45 offset:84
    s_add_u32 s40, s40, 1
    s_cmp_ge_u32 s40, 0x40000
    s_cbranch_scc1 L_m5dCs
    s_waitcnt lgkmcnt(0)
    v_cmp_eq_u32 vcc, 0, v108
    s_cbranch_vccnz L_m5rCs
    s_branch L_m5dCs
L_m6rCs:
    ds_read_b32 v108, v45 offset:88
    s_add_u32 s40, s40, 1
    s_cmp_ge_u32 s40, 0x40000
    s_cbranch_scc1 L_m6dCs
    s_waitcnt lgkmcnt(0)
    v_cmp_eq_u32 vcc, 0, v108
    s_cbranch_vccnz L_m6rCs
    s_branch L_m6dCs
L_m7rCs:
    ds_read_b32 v108, v45 offset:92
    s_add_u32 s40, s40, 1
    s_cmp_ge_u32 s40, 0x40000
    s_cbranch_scc1 L_m7dCs
    s_waitcnt lgkmcnt(0)
    v_cmp_eq_u32 vcc, 0, v108
    s_cbranch_vccnz L_m7rCs
    s_branch L_m7dCs
L_m8rCs:
    ds_read_b32 v108, v45 offset:96
    s_add_u32 s40, s40, 1
    s_cmp_ge_u32 s40, 0x40000
    s_cbranch_scc1 L_m8dCs
    s_waitcnt lgkmcnt(0)
    v_cmp_eq_u32 vcc, 0, v108
    s_cbranch_vccnz L_m8rCs
    s_branch L_m8dCs
L_m9rCs:
    ds_read_b32 v108, v45 offset:100
    s_add_u32 s40, s40, 1
    s_cmp_ge_u32 s40, 0x40000
    s_cbranch_scc1 L_m9dCs
    s_waitcnt lgkmcnt(0)
    v_cmp_eq_u32 vcc, 0, v108
    s_cbranch_vccnz L_m9rCs
    s_branch L_m9dCs
L_m10rCs:
    ds_read_b32 v108, v45 offset:104
    s_add_u32 s40, s40, 1
    s_cmp_ge_u32 s40, 0x40000
    s_cbranch_scc1 L_m10dCs
    s_waitcnt lgkmcnt(0)
    v_cmp_eq_u32 vcc, 0, v108
    s_cbranch_vccnz L_m10rCs
    s_branch L_m10dCs
L_m11rCs:
    ds_read_b32 v108, v45 offset:108
    s_add_u32 s40, s40, 1
    s_cmp_ge_u32 s40, 0x40000
    s_cbranch_scc1 L_m11dCs
    s_waitcnt lgkmcnt(0)
    v_cmp_eq_u32 vcc, 0, v108
    s_cbranch_vccnz L_m11rCs
    s_branch L_m11dCs
L_m12rCs:
    ds_read_b32 v108, v45 offset:112
    s_add_u32 s40, s40, 1
    s_cmp_ge_u32 s40, 0x40000
    s_cbranch_scc1 L_m12dCs
    s_waitcnt lgkmcnt(0)
    v_cmp_eq_u32 vcc, 0, v108
    s_cbranch_vccnz L_m12rCs
    s_branch L_m12dCs
L_attnCq:
    s_load_dword s39, s[20:21], 111360 glc
    s_waitcnt lgkmcnt(0)
    s_cmp_eq_u32 s39, s3
    s_cbranch_scc1 L_attnCf
    s_add_u32 s64, s64, 4194304
    s_addc_u32 s65, s65, 0
    s_add_u32 s4, s26, 8388608
    s_addc_u32 s5, s27, 0
    s_mov_b32 s62, 0
    s_branch L_attnCs
L_attnLq:
    s_load_dword s39, s[20:21], 111360 glc
    s_waitcnt lgkmcnt(0)
    s_cmp_eq_u32 s39, s3
    s_cbranch_scc1 L_attnLf
    s_add_u32 s64, s64, 4194304
    s_addc_u32 s65, s65, 0
    s_add_u32 s4, s26, 8388608
    s_addc_u32 s5, s27, 0
    s_mov_b32 s62, 0
    s_branch L_attnLs
    .fill 512, 4, 0xbf810000
L_last:
.section .rodata,"a"
.p2align 6
.amdhsa_kernel standalone__sliding_local_dilated__prompt_kernel
  .amdhsa_next_free_vgpr 256
  .amdhsa_next_free_sgpr 102
  .amdhsa_accum_offset 256
  .amdhsa_group_segment_fixed_size 0
  .amdhsa_kernarg_size 48
  .amdhsa_user_sgpr_count 2
  .amdhsa_user_sgpr_kernarg_segment_ptr 1
  .amdhsa_system_sgpr_workgroup_id_x 1
.end_amdhsa_kernel
```
